```python
import torch

def _softmax(x, axis=-1):
    return torch.softmax(x, dim=axis)
def _gelu(x):
    return torch.nn.functional.gelu(x, approximate="tanh")
def _silu(x):
    return torch.nn.functional.silu(x)
def _sigmoid(x):
    return torch.sigmoid(x)
def _layernorm(x, axis=-1, eps=1e-5):
    m = x.mean(dim=axis, keepdim=True)
    v = x.var(dim=axis, keepdim=True, unbiased=False)
    return (x - m) / torch.sqrt(v + eps)
def _scatter_add(tgt, idx, src, axis=0):
    return tgt.clone().index_add_(axis, idx, src)
def _segment_sum(src, seg, n):
    out = torch.zeros((n,) + src.shape[1:], dtype=src.dtype)
    return out.index_add_(0, seg, src)
def _pad(x, pw):
    flat = tuple(v for pair in reversed(pw) for v in pair)
    return torch.nn.functional.pad(x, flat)

kernel_name = 'gated_mix__gqa_block_cached__geglu_ffn__decode'

def setup_inputs():

    _w = (lambda a: (lambda t: t.to(torch.bfloat16) if t.is_floating_point() else t)(torch.as_tensor(a)))
    def _A_setup():
        B, Sq, D = 1, 1, 448
        Hq, Hkv, Sk, Dh = 16, 8, 65536, 256
        assert Hq % Hkv == 0, (Hq, Hkv)
        return {
            "x": _w((lambda *s: torch.randn(*s, dtype=torch.bfloat16) * 0.05)(B, Sq, D)),
            "k_cache": _w((lambda *s: torch.randn(*s, dtype=torch.bfloat16) * 6.4)(B, Hkv, Sk, Dh)),
            "v_cache": _w((lambda *s: torch.randn(*s, dtype=torch.bfloat16) * 0.2)(B, Hkv, Sk, Dh)),
            "wq": _w((lambda *s: torch.randn(*s, dtype=torch.bfloat16) * 6.4)(D, Hq * Dh) * (D ** -0.5)),
            "wo": _w((lambda *s: torch.randn(*s, dtype=torch.bfloat16) * 0.2)(Hq * Dh, D) * ((Hq * Dh) ** -0.5)),
        }
    _A_in = _A_setup()

    def _B_setup():
        B, S, D, F = 1, 1, 448, 1792
        return {
            "x": _w((lambda *s: torch.randn(*s, dtype=torch.bfloat16) * 0.05)(B, S, D)),
            "w_gate": _w((lambda *s: torch.randn(*s, dtype=torch.bfloat16) * 0.05)(D, F)),
            "w_up": _w((lambda *s: torch.randn(*s, dtype=torch.bfloat16) * 0.05)(D, F)),
            "w_down": _w((lambda *s: torch.randn(*s, dtype=torch.bfloat16) * 0.05)(F, D)),
        }
    _B_in = _B_setup()

    return {
        "A_x": _A_in["x"],
        "A_k_cache": _A_in["k_cache"],
        "A_v_cache": _A_in["v_cache"],
        "A_wq": _A_in["wq"],
        "A_wo": _A_in["wo"],
        "B_x": _B_in["x"],
        "B_w_gate": _B_in["w_gate"],
        "B_w_up": _B_in["w_up"],
        "B_w_down": _B_in["w_down"],
        "gate_w": _w((lambda *s: torch.randn(*s, dtype=torch.bfloat16) * 0.05)(448) * 16.0),
    }

def reference(A_x, A_k_cache, A_v_cache, A_wq, A_wo, B_x, B_w_gate, B_w_up, B_w_down, gate_w):
    def _A_ref(x, k_cache, v_cache, wq, wo):
        B, Sq, D = x.shape
        Hq, Dh = 16, 256
        Hkv = k_cache.shape[1]
        rep = Hq // Hkv
        q = (lambda x, *d: x.permute(*d))((x @ wq).reshape(B, Sq, Hq, Dh), 0, 2, 1, 3)
        k = (lambda x, n, axis: torch.repeat_interleave(x, n, dim=axis))(k_cache, rep, axis=1)
        v = (lambda x, n, axis: torch.repeat_interleave(x, n, dim=axis))(v_cache, rep, axis=1)
        scores = torch.einsum("bhqd,bhkd->bhqk", q, k) * (Dh ** -0.5)
        p = _softmax(scores, axis=-1)
        o = torch.einsum("bhqk,bhkd->bhqd", p, v)
        return (lambda x, *d: x.permute(*d))(o, 0, 2, 1, 3).reshape(B, Sq, Hq * Dh) @ wo

    def _B_ref(x, w_gate, w_up, w_down):
        return (_gelu(x @ w_gate) * (x @ w_up)) @ w_down

    x = A_x
    g = _sigmoid((x * gate_w).sum(-1, keepdims=True))
    a = _A_ref(x, A_k_cache, A_v_cache, A_wq, A_wo)
    b = _B_ref(x, B_w_gate, B_w_up, B_w_down)
    return g * a + (1 - g) * b
```

```asm
; @launch grid=(256,1,1) block=(320,1,1) lds=18816
.amdgcn_target "amdgcn-amd-amdhsa--gfx950"
.text
.globl gated_mix__gqa_block_cached__geglu_ffn__decode_kernel
.p2align 8
.type gated_mix__gqa_block_cached__geglu_ffn__decode_kernel,@function
gated_mix__gqa_block_cached__geglu_ffn__decode_kernel:
    s_cmp_ge_u32 s2, 256
    s_cbranch_scc1 L_end
    s_load_dwordx16 s[16:31], s[0:1], 0
    s_load_dwordx8 s[32:39], s[0:1], 64
    s_load_dwordx2 s[40:41], s[0:1], 96
    v_lshrrev_b32 v1, 6, v0
    s_nop 0
    v_readfirstlane_b32 s3, v1
    v_and_b32 v0, 63, v0
    s_and_b32 s42, s2, 7
    s_lshr_b32 s43, s2, 3
    s_add_u32 s4, s43, s42
    s_and_b32 s4, s4, 7
    s_lshr_b32 s5, s2, 6
    s_lshl_b32 s5, s5, 3
    s_add_u32 s5, s5, s42
    v_and_b32 v4, 15, v0
    v_lshrrev_b32 v5, 4, v0
    s_cmp_eq_u32 s3, 4
    s_cbranch_scc1 L_helper
    v_lshrrev_b32 v1, 2, v4
    v_lshlrev_b32 v1, 9, v1
    v_and_b32 v2, 3, v4
    v_lshl_add_u32 v1, v2, 6, v1
    v_lshl_add_u32 v1, v5, 4, v1
    v_lshlrev_b32 v2, 9, v5
    v_lshl_add_u32 v2, v4, 4, v2
    s_lshl_b32 s52, s3, 13
    s_lshl_b32 s7, s4, 25
    s_lshl_b32 s6, s5, 15
    s_add_u32 s7, s7, s6
    s_sub_u32 s46, 0x2000000, s6
    s_mov_b32 s47, 0x00020000
    s_mov_b32 s50, s46
    s_mov_b32 s51, 0x00020000
    s_and_b32 s9, s4, 3
    s_lshl_b32 s9, s9, 11
    s_add_u32 s8, s52, s9
    s_waitcnt lgkmcnt(0)
    s_add_u32 s44, s18, s7
    s_addc_u32 s45, s19, 0
    s_add_u32 s48, s20, s7
    s_addc_u32 s49, s21, 0
    buffer_load_dwordx4 v[8:11], v1, s[44:47], s8 offen offset:0 nt
    buffer_load_dwordx4 v[12:15], v1, s[44:47], s8 offen offset:256 nt
    buffer_load_dwordx4 v[16:19], v2, s[48:51], s8 offen offset:0 nt
    buffer_load_dwordx4 v[20:23], v2, s[48:51], s8 offen offset:256 nt
    s_add_u32 s9, s9, 0x800
    s_and_b32 s9, s9, 0x1fff
    s_add_u32 s8, s52, s9
    buffer_load_dwordx4 v[24:27], v1, s[44:47], s8 offen offset:0 nt
    buffer_load_dwordx4 v[28:31], v1, s[44:47], s8 offen offset:256 nt
    v_and_b32 v6, 1, v4
    v_lshlrev_b32 v6, 4, v6
    v_mov_b32 v7, 0xffff
    v_lshlrev_b32 v7, v6, v7
    v_lshrrev_b32 v6, 1, v4
    v_and_b32 v6, 3, v6
    v_cmp_eq_u32 vcc, 0, v6
    s_nop 1
    v_cndmask_b32 v232, 0, v7, vcc
    v_cmp_eq_u32 vcc, 1, v6
    s_nop 1
    v_cndmask_b32 v233, 0, v7, vcc
    v_cmp_eq_u32 vcc, 2, v6
    s_nop 1
    v_cndmask_b32 v234, 0, v7, vcc
    v_cmp_eq_u32 vcc, 3, v6
    s_nop 1
    v_cndmask_b32 v235, 0, v7, vcc
    v_lshrrev_b32 v6, 1, v5
    v_lshlrev_b32 v6, 10, v6
    v_and_b32 v7, 1, v5
    v_lshl_add_u32 v6, v7, 4, v6
    v_lshl_add_u32 v6, v4, 5, v6
    s_lshl_b32 s6, s3, 11
    s_add_u32 s6, s6, 1024
    v_add_u32 v3, s6, v6
    v_lshrrev_b32 v6, 3, v4
    v_lshlrev_b32 v7, 9, v6
    v_lshl_add_u32 v7, v5, 4, v7
    v_and_b32 v239, 3, v4
    v_lshl_add_u32 v7, v239, 6, v7
    v_lshrrev_b32 v239, 1, v5
    v_cmp_eq_u32 s[12:13], v6, v239
    v_mov_b32 v6, 9344
    v_mov_b32 v245, 9348
    v_mov_b32 v246, 0x2000
    s_lshl_b32 s6, s3, 2
    s_add_u32 s6, s6, 9600
    v_lshlrev_b32 v248, 4, v0
    v_add_u32 v248, s6, v248
    v_mov_b32 v247, 14
    v_mov_b32 v208, 0
    v_mov_b32 v209, 0
    v_mov_b32 v210, 0
    v_mov_b32 v211, 0
    v_mov_b32 v212, 0
    v_mov_b32 v213, 0
    v_mov_b32 v214, 0
    v_mov_b32 v215, 0
    v_mov_b32 v236, 0xff800000
    v_mov_b32 v237, 0
    s_mov_b32 s14, 0x3db8aa3b
    s_mov_b32 s10, 2
    s_mov_b32 s11, 0
    s_mov_b32 s53, 589824
    s_mov_b32 s54, 0
    s_mov_b32 s56, 0
    s_mov_b32 s65, 0
    s_mov_b32 s64, 0
    s_mov_b32 s58, 4
    s_mov_b32 s60, 0
    s_mov_b32 s55, 4
    s_mov_b32 s59, 0
    s_barrier
    s_waitcnt vmcnt(4)
    buffer_load_dwordx4 v[32:35], v2, s[48:51], s8 offen offset:0 nt
    buffer_load_dwordx4 v[36:39], v2, s[48:51], s8 offen offset:256 nt
    s_add_u32 s9, s9, 0x800
    s_and_b32 s9, s9, 0x1fff
    s_add_u32 s8, s52, s9
    s_waitcnt vmcnt(4)
    buffer_load_dwordx4 v[40:43], v1, s[44:47], s8 offen offset:0 nt
    buffer_load_dwordx4 v[44:47], v1, s[44:47], s8 offen offset:256 nt
    s_waitcnt vmcnt(4)
    buffer_load_dwordx4 v[48:51], v2, s[48:51], s8 offen offset:0 nt
    buffer_load_dwordx4 v[52:55], v2, s[48:51], s8 offen offset:256 nt
    s_add_u32 s9, s9, 0x800
    s_and_b32 s9, s9, 0x1fff
    s_add_u32 s8, s52, s9
    s_waitcnt vmcnt(4)
    buffer_load_dwordx4 v[56:59], v1, s[44:47], s8 offen offset:0 nt
    buffer_load_dwordx4 v[60:63], v1, s[44:47], s8 offen offset:256 nt
    s_waitcnt vmcnt(4)
    buffer_load_dwordx4 v[64:67], v2, s[48:51], s8 offen offset:0 nt
    buffer_load_dwordx4 v[68:71], v2, s[48:51], s8 offen offset:256 nt
    s_add_u32 s52, s52, 0x100000
    s_add_u32 s9, s9, 0x800
    s_and_b32 s9, s9, 0x1fff
    s_add_u32 s8, s52, s9
    s_waitcnt vmcnt(4)
    buffer_load_dwordx4 v[72:75], v1, s[44:47], s8 offen offset:0 nt
    buffer_load_dwordx4 v[76:79], v1, s[44:47], s8 offen offset:256 nt
    s_waitcnt vmcnt(4)
    buffer_load_dwordx4 v[80:83], v2, s[48:51], s8 offen offset:0 nt
    buffer_load_dwordx4 v[84:87], v2, s[48:51], s8 offen offset:256 nt
    s_add_u32 s9, s9, 0x800
    s_and_b32 s9, s9, 0x1fff
    s_add_u32 s8, s52, s9
    s_waitcnt vmcnt(4)
    buffer_load_dwordx4 v[88:91], v1, s[44:47], s8 offen offset:0 nt
    buffer_load_dwordx4 v[92:95], v1, s[44:47], s8 offen offset:256 nt
    s_waitcnt vmcnt(4)
    buffer_load_dwordx4 v[96:99], v2, s[48:51], s8 offen offset:0 nt
    buffer_load_dwordx4 v[100:103], v2, s[48:51], s8 offen offset:256 nt
    s_add_u32 s9, s9, 0x800
    s_and_b32 s9, s9, 0x1fff
    s_add_u32 s8, s52, s9
    s_waitcnt vmcnt(4)
    buffer_load_dwordx4 v[104:107], v1, s[44:47], s8 offen offset:0 nt
    buffer_load_dwordx4 v[108:111], v1, s[44:47], s8 offen offset:256 nt
    s_waitcnt vmcnt(4)
    buffer_load_dwordx4 v[112:115], v2, s[48:51], s8 offen offset:0 nt
    buffer_load_dwordx4 v[116:119], v2, s[48:51], s8 offen offset:256 nt
    s_add_u32 s9, s9, 0x800
    s_and_b32 s9, s9, 0x1fff
    s_add_u32 s8, s52, s9
    s_waitcnt vmcnt(4)
    buffer_load_dwordx4 v[120:123], v1, s[44:47], s8 offen offset:0 nt
    buffer_load_dwordx4 v[124:127], v1, s[44:47], s8 offen offset:256 nt
    s_waitcnt vmcnt(4)
    buffer_load_dwordx4 v[128:131], v2, s[48:51], s8 offen offset:0 nt
    buffer_load_dwordx4 v[132:135], v2, s[48:51], s8 offen offset:256 nt
    s_add_u32 s52, s52, 0x100000
    s_add_u32 s9, s9, 0x800
    s_and_b32 s9, s9, 0x1fff
    s_add_u32 s8, s52, s9
    s_waitcnt vmcnt(4)
    buffer_load_dwordx4 v[136:139], v1, s[44:47], s8 offen offset:0 nt
    buffer_load_dwordx4 v[140:143], v1, s[44:47], s8 offen offset:256 nt
    s_waitcnt vmcnt(4)
    buffer_load_dwordx4 v[144:147], v2, s[48:51], s8 offen offset:0 nt
    buffer_load_dwordx4 v[148:151], v2, s[48:51], s8 offen offset:256 nt
    s_add_u32 s9, s9, 0x800
    s_and_b32 s9, s9, 0x1fff
    s_add_u32 s8, s52, s9
    s_waitcnt vmcnt(4)
    buffer_load_dwordx4 v[152:155], v1, s[44:47], s8 offen offset:0 nt
    buffer_load_dwordx4 v[156:159], v1, s[44:47], s8 offen offset:256 nt
    s_waitcnt vmcnt(4)
    buffer_load_dwordx4 v[160:163], v2, s[48:51], s8 offen offset:0 nt
    buffer_load_dwordx4 v[164:167], v2, s[48:51], s8 offen offset:256 nt
    s_add_u32 s9, s9, 0x800
    s_and_b32 s9, s9, 0x1fff
    s_add_u32 s8, s52, s9
    s_waitcnt vmcnt(4)
    buffer_load_dwordx4 v[168:171], v1, s[44:47], s8 offen offset:0 nt
    buffer_load_dwordx4 v[172:175], v1, s[44:47], s8 offen offset:256 nt
    s_waitcnt vmcnt(4)
    buffer_load_dwordx4 v[176:179], v2, s[48:51], s8 offen offset:0 nt
    buffer_load_dwordx4 v[180:183], v2, s[48:51], s8 offen offset:256 nt
    s_add_u32 s9, s9, 0x800
    s_and_b32 s9, s9, 0x1fff
    s_add_u32 s8, s52, s9
    s_waitcnt vmcnt(4)
    buffer_load_dwordx4 v[184:187], v1, s[44:47], s8 offen offset:0 nt
    buffer_load_dwordx4 v[188:191], v1, s[44:47], s8 offen offset:256 nt
    s_waitcnt vmcnt(4)
    buffer_load_dwordx4 v[192:195], v2, s[48:51], s8 offen offset:0 nt
    buffer_load_dwordx4 v[196:199], v2, s[48:51], s8 offen offset:256 nt
    s_add_u32 s52, s52, 0x100000
    s_add_u32 s9, s9, 0x800
    s_and_b32 s9, s9, 0x1fff
    s_add_u32 s8, s52, s9
L_qw:
    ds_read_b32 v239, v6
    ds_read_b128 v[200:203], v7 offset:0
    ds_read_b128 v[204:207], v7 offset:256
    s_add_u32 s59, s59, 1
    s_waitcnt lgkmcnt(0)
    v_readfirstlane_b32 s6, v239
    s_cmp_ge_u32 s59, 1048576
    s_cbranch_scc1 L_qok
    s_cmp_eq_u32 s6, 0
    s_cbranch_scc1 L_qw
L_qok:
    s_mov_b32 s59, 0
    v_mfma_f32_16x16x32_bf16 v[216:219], v[8:11], v[200:203], 0
    v_mfma_f32_16x16x32_bf16 v[216:219], v[12:15], v[204:207], v[216:219]
    s_waitcnt vmcnt(4)
    buffer_load_dwordx4 v[8:11], v1, s[44:47], s8 offen offset:0 nt
    buffer_load_dwordx4 v[12:15], v1, s[44:47], s8 offen offset:256 nt
    v_mfma_f32_16x16x32_bf16 v[220:223], v[24:27], v[200:203], 0
    v_mfma_f32_16x16x32_bf16 v[220:223], v[28:31], v[204:207], v[220:223]
    s_nop 2
    v_mov_b32_dpp v239, v216 quad_perm:[0,0,0,0] row_mask:0xf bank_mask:0xf
    v_mov_b32_dpp v240, v218 quad_perm:[2,2,2,2] row_mask:0xf bank_mask:0xf
    s_nop 0
    v_add_f32_dpp v239, v217, v239 quad_perm:[1,1,1,1] row_mask:0xf bank_mask:0xf
    v_add_f32_dpp v240, v219, v240 quad_perm:[3,3,3,3] row_mask:0xf bank_mask:0xf
    v_add_f32 v239, v239, v240
    v_cvt_pk_bf16_f32 v239, v239, v239
    v_and_b32 v241, 0xffff0000, v239
    v_fma_f32 v238, v241, s14, -v236
    v_cmp_lt_f32 vcc, 0, v238
    s_cbranch_vccnz SLOW_1
BACK_2:
    v_exp_f32 v238, v238
    s_nop 0
    v_cvt_pk_bf16_f32 v239, v238, v238
    v_and_b32 v224, v239, v232
    v_and_b32 v225, v239, v233
    v_and_b32 v226, v239, v234
    v_and_b32 v227, v239, v235
    v_add_f32 v237, v237, v238
    s_nop 0
    v_mfma_f32_16x16x32_bf16 v[208:211], v[224:227], v[16:19], v[208:211]
    v_mfma_f32_16x16x32_bf16 v[212:215], v[224:227], v[20:23], v[212:215]
    v_mfma_f32_16x16x32_bf16 v[216:219], v[40:43], v[200:203], 0
    v_mfma_f32_16x16x32_bf16 v[216:219], v[44:47], v[204:207], v[216:219]
    v_mov_b32_dpp v239, v220 quad_perm:[0,0,0,0] row_mask:0xf bank_mask:0xf
    v_mov_b32_dpp v240, v222 quad_perm:[2,2,2,2] row_mask:0xf bank_mask:0xf
    s_nop 0
    v_add_f32_dpp v239, v221, v239 quad_perm:[1,1,1,1] row_mask:0xf bank_mask:0xf
    v_add_f32_dpp v240, v223, v240 quad_perm:[3,3,3,3] row_mask:0xf bank_mask:0xf
    v_add_f32 v239, v239, v240
    v_cvt_pk_bf16_f32 v239, v239, v239
    v_and_b32 v241, 0xffff0000, v239
    v_fma_f32 v238, v241, s14, -v236
    v_cmp_lt_f32 vcc, 0, v238
    s_cbranch_vccnz SLOW_3
BACK_4:
    v_exp_f32 v238, v238
    s_nop 0
    v_cvt_pk_bf16_f32 v239, v238, v238
    v_and_b32 v228, v239, v232
    v_and_b32 v229, v239, v233
    v_and_b32 v230, v239, v234
    v_and_b32 v231, v239, v235
    v_add_f32 v237, v237, v238
    s_nop 0
    v_mfma_f32_16x16x32_bf16 v[208:211], v[228:231], v[32:35], v[208:211]
    v_mfma_f32_16x16x32_bf16 v[212:215], v[228:231], v[36:39], v[212:215]
    v_mfma_f32_16x16x32_bf16 v[220:223], v[56:59], v[200:203], 0
    v_mfma_f32_16x16x32_bf16 v[220:223], v[60:63], v[204:207], v[220:223]
    v_mov_b32_dpp v239, v216 quad_perm:[0,0,0,0] row_mask:0xf bank_mask:0xf
    v_mov_b32_dpp v240, v218 quad_perm:[2,2,2,2] row_mask:0xf bank_mask:0xf
    s_nop 0
    v_add_f32_dpp v239, v217, v239 quad_perm:[1,1,1,1] row_mask:0xf bank_mask:0xf
    v_add_f32_dpp v240, v219, v240 quad_perm:[3,3,3,3] row_mask:0xf bank_mask:0xf
    v_add_f32 v239, v239, v240
    v_cvt_pk_bf16_f32 v239, v239, v239
    v_and_b32 v241, 0xffff0000, v239
    v_fma_f32 v238, v241, s14, -v236
    v_cmp_lt_f32 vcc, 0, v238
    s_cbranch_vccnz SLOW_5
BACK_6:
    v_exp_f32 v238, v238
    s_nop 0
    v_cvt_pk_bf16_f32 v239, v238, v238
    v_and_b32 v224, v239, v232
    v_and_b32 v225, v239, v233
    v_and_b32 v226, v239, v234
    v_and_b32 v227, v239, v235
    v_add_f32 v237, v237, v238
    s_nop 0
    v_mfma_f32_16x16x32_bf16 v[208:211], v[224:227], v[48:51], v[208:211]
    v_mfma_f32_16x16x32_bf16 v[212:215], v[224:227], v[52:55], v[212:215]
    s_waitcnt vmcnt(4)
    buffer_load_dwordx4 v[16:19], v2, s[48:51], s8 offen offset:0 nt
    buffer_load_dwordx4 v[20:23], v2, s[48:51], s8 offen offset:256 nt
    s_add_u32 s9, s9, 0x800
    s_and_b32 s9, s9, 0x1fff
    s_add_u32 s8, s52, s9
    v_mfma_f32_16x16x32_bf16 v[216:219], v[72:75], v[200:203], 0
    v_mfma_f32_16x16x32_bf16 v[216:219], v[76:79], v[204:207], v[216:219]
    v_mov_b32_dpp v239, v220 quad_perm:[0,0,0,0] row_mask:0xf bank_mask:0xf
    v_mov_b32_dpp v240, v222 quad_perm:[2,2,2,2] row_mask:0xf bank_mask:0xf
    s_nop 0
    v_add_f32_dpp v239, v221, v239 quad_perm:[1,1,1,1] row_mask:0xf bank_mask:0xf
    v_add_f32_dpp v240, v223, v240 quad_perm:[3,3,3,3] row_mask:0xf bank_mask:0xf
    v_add_f32 v239, v239, v240
    v_cvt_pk_bf16_f32 v239, v239, v239
    v_and_b32 v241, 0xffff0000, v239
    v_fma_f32 v238, v241, s14, -v236
    v_cmp_lt_f32 vcc, 0, v238
    s_cbranch_vccnz SLOW_7
BACK_8:
    v_exp_f32 v238, v238
    s_nop 0
    v_cvt_pk_bf16_f32 v239, v238, v238
    v_and_b32 v228, v239, v232
    v_and_b32 v229, v239, v233
    v_and_b32 v230, v239, v234
    v_and_b32 v231, v239, v235
    v_add_f32 v237, v237, v238
    s_nop 0
    v_mfma_f32_16x16x32_bf16 v[208:211], v[228:231], v[64:67], v[208:211]
    v_mfma_f32_16x16x32_bf16 v[212:215], v[228:231], v[68:71], v[212:215]
    v_mfma_f32_16x16x32_bf16 v[220:223], v[88:91], v[200:203], 0
    v_mfma_f32_16x16x32_bf16 v[220:223], v[92:95], v[204:207], v[220:223]
    v_mov_b32_dpp v239, v216 quad_perm:[0,0,0,0] row_mask:0xf bank_mask:0xf
    v_mov_b32_dpp v240, v218 quad_perm:[2,2,2,2] row_mask:0xf bank_mask:0xf
    s_nop 0
    v_add_f32_dpp v239, v217, v239 quad_perm:[1,1,1,1] row_mask:0xf bank_mask:0xf
    v_add_f32_dpp v240, v219, v240 quad_perm:[3,3,3,3] row_mask:0xf bank_mask:0xf
    v_add_f32 v239, v239, v240
    v_cvt_pk_bf16_f32 v239, v239, v239
    v_and_b32 v241, 0xffff0000, v239
    v_fma_f32 v238, v241, s14, -v236
    v_cmp_lt_f32 vcc, 0, v238
    s_cbranch_vccnz SLOW_9
BACK_10:
    v_exp_f32 v238, v238
    s_nop 0
    v_cvt_pk_bf16_f32 v239, v238, v238
    v_and_b32 v224, v239, v232
    v_and_b32 v225, v239, v233
    v_and_b32 v226, v239, v234
    v_and_b32 v227, v239, v235
    v_add_f32 v237, v237, v238
    s_nop 0
    v_mfma_f32_16x16x32_bf16 v[208:211], v[224:227], v[80:83], v[208:211]
    v_mfma_f32_16x16x32_bf16 v[212:215], v[224:227], v[84:87], v[212:215]
    v_mfma_f32_16x16x32_bf16 v[216:219], v[104:107], v[200:203], 0
    v_mfma_f32_16x16x32_bf16 v[216:219], v[108:111], v[204:207], v[216:219]
    v_mov_b32_dpp v239, v220 quad_perm:[0,0,0,0] row_mask:0xf bank_mask:0xf
    v_mov_b32_dpp v240, v222 quad_perm:[2,2,2,2] row_mask:0xf bank_mask:0xf
    s_nop 0
    v_add_f32_dpp v239, v221, v239 quad_perm:[1,1,1,1] row_mask:0xf bank_mask:0xf
    v_add_f32_dpp v240, v223, v240 quad_perm:[3,3,3,3] row_mask:0xf bank_mask:0xf
    v_add_f32 v239, v239, v240
    v_cvt_pk_bf16_f32 v239, v239, v239
    v_and_b32 v241, 0xffff0000, v239
    v_fma_f32 v238, v241, s14, -v236
    v_cmp_lt_f32 vcc, 0, v238
    s_cbranch_vccnz SLOW_11
BACK_12:
    v_exp_f32 v238, v238
    s_nop 0
    v_cvt_pk_bf16_f32 v239, v238, v238
    v_and_b32 v228, v239, v232
    v_and_b32 v229, v239, v233
    v_and_b32 v230, v239, v234
    v_and_b32 v231, v239, v235
    v_add_f32 v237, v237, v238
    s_nop 0
    v_mfma_f32_16x16x32_bf16 v[208:211], v[228:231], v[96:99], v[208:211]
    v_mfma_f32_16x16x32_bf16 v[212:215], v[228:231], v[100:103], v[212:215]
    s_waitcnt vmcnt(4)
    buffer_load_dwordx4 v[24:27], v1, s[44:47], s8 offen offset:0 nt
    buffer_load_dwordx4 v[28:31], v1, s[44:47], s8 offen offset:256 nt
    v_mfma_f32_16x16x32_bf16 v[220:223], v[120:123], v[200:203], 0
    v_mfma_f32_16x16x32_bf16 v[220:223], v[124:127], v[204:207], v[220:223]
    v_mov_b32_dpp v239, v216 quad_perm:[0,0,0,0] row_mask:0xf bank_mask:0xf
    v_mov_b32_dpp v240, v218 quad_perm:[2,2,2,2] row_mask:0xf bank_mask:0xf
    s_nop 0
    v_add_f32_dpp v239, v217, v239 quad_perm:[1,1,1,1] row_mask:0xf bank_mask:0xf
    v_add_f32_dpp v240, v219, v240 quad_perm:[3,3,3,3] row_mask:0xf bank_mask:0xf
    v_add_f32 v239, v239, v240
    v_cvt_pk_bf16_f32 v239, v239, v239
    v_and_b32 v241, 0xffff0000, v239
    v_fma_f32 v238, v241, s14, -v236
    v_cmp_lt_f32 vcc, 0, v238
    s_cbranch_vccnz SLOW_13
BACK_14:
    v_exp_f32 v238, v238
    s_nop 0
    v_cvt_pk_bf16_f32 v239, v238, v238
    v_and_b32 v224, v239, v232
    v_and_b32 v225, v239, v233
    v_and_b32 v226, v239, v234
    v_and_b32 v227, v239, v235
    v_add_f32 v237, v237, v238
    s_nop 0
    v_mfma_f32_16x16x32_bf16 v[208:211], v[224:227], v[112:115], v[208:211]
    v_mfma_f32_16x16x32_bf16 v[212:215], v[224:227], v[116:119], v[212:215]
    v_mfma_f32_16x16x32_bf16 v[216:219], v[136:139], v[200:203], 0
    v_mfma_f32_16x16x32_bf16 v[216:219], v[140:143], v[204:207], v[216:219]
    v_mov_b32_dpp v239, v220 quad_perm:[0,0,0,0] row_mask:0xf bank_mask:0xf
    v_mov_b32_dpp v240, v222 quad_perm:[2,2,2,2] row_mask:0xf bank_mask:0xf
    s_nop 0
    v_add_f32_dpp v239, v221, v239 quad_perm:[1,1,1,1] row_mask:0xf bank_mask:0xf
    v_add_f32_dpp v240, v223, v240 quad_perm:[3,3,3,3] row_mask:0xf bank_mask:0xf
    v_add_f32 v239, v239, v240
    v_cvt_pk_bf16_f32 v239, v239, v239
    v_and_b32 v241, 0xffff0000, v239
    v_fma_f32 v238, v241, s14, -v236
    v_cmp_lt_f32 vcc, 0, v238
    s_cbranch_vccnz SLOW_15
BACK_16:
    v_exp_f32 v238, v238
    s_nop 0
    v_cvt_pk_bf16_f32 v239, v238, v238
    v_and_b32 v228, v239, v232
    v_and_b32 v229, v239, v233
    v_and_b32 v230, v239, v234
    v_and_b32 v231, v239, v235
    v_add_f32 v237, v237, v238
    s_nop 0
    v_mfma_f32_16x16x32_bf16 v[208:211], v[228:231], v[128:131], v[208:211]
    v_mfma_f32_16x16x32_bf16 v[212:215], v[228:231], v[132:135], v[212:215]
    v_mfma_f32_16x16x32_bf16 v[220:223], v[152:155], v[200:203], 0
    v_mfma_f32_16x16x32_bf16 v[220:223], v[156:159], v[204:207], v[220:223]
    v_mov_b32_dpp v239, v216 quad_perm:[0,0,0,0] row_mask:0xf bank_mask:0xf
    v_mov_b32_dpp v240, v218 quad_perm:[2,2,2,2] row_mask:0xf bank_mask:0xf
    s_nop 0
    v_add_f32_dpp v239, v217, v239 quad_perm:[1,1,1,1] row_mask:0xf bank_mask:0xf
    v_add_f32_dpp v240, v219, v240 quad_perm:[3,3,3,3] row_mask:0xf bank_mask:0xf
    v_add_f32 v239, v239, v240
    v_cvt_pk_bf16_f32 v239, v239, v239
    v_and_b32 v241, 0xffff0000, v239
    v_fma_f32 v238, v241, s14, -v236
    v_cmp_lt_f32 vcc, 0, v238
    s_cbranch_vccnz SLOW_17
BACK_18:
    v_exp_f32 v238, v238
    s_nop 0
    v_cvt_pk_bf16_f32 v239, v238, v238
    v_and_b32 v224, v239, v232
    v_and_b32 v225, v239, v233
    v_and_b32 v226, v239, v234
    v_and_b32 v227, v239, v235
    v_add_f32 v237, v237, v238
    s_nop 0
    v_mfma_f32_16x16x32_bf16 v[208:211], v[224:227], v[144:147], v[208:211]
    v_mfma_f32_16x16x32_bf16 v[212:215], v[224:227], v[148:151], v[212:215]
    s_waitcnt vmcnt(4)
    buffer_load_dwordx4 v[32:35], v2, s[48:51], s8 offen offset:0 nt
    buffer_load_dwordx4 v[36:39], v2, s[48:51], s8 offen offset:256 nt
    s_add_u32 s9, s9, 0x800
    s_and_b32 s9, s9, 0x1fff
    s_add_u32 s8, s52, s9
    v_mfma_f32_16x16x32_bf16 v[216:219], v[168:171], v[200:203], 0
    v_mfma_f32_16x16x32_bf16 v[216:219], v[172:175], v[204:207], v[216:219]
    v_mov_b32_dpp v239, v220 quad_perm:[0,0,0,0] row_mask:0xf bank_mask:0xf
    v_mov_b32_dpp v240, v222 quad_perm:[2,2,2,2] row_mask:0xf bank_mask:0xf
    s_nop 0
    v_add_f32_dpp v239, v221, v239 quad_perm:[1,1,1,1] row_mask:0xf bank_mask:0xf
    v_add_f32_dpp v240, v223, v240 quad_perm:[3,3,3,3] row_mask:0xf bank_mask:0xf
    v_add_f32 v239, v239, v240
    v_cvt_pk_bf16_f32 v239, v239, v239
    v_and_b32 v241, 0xffff0000, v239
    v_fma_f32 v238, v241, s14, -v236
    v_cmp_lt_f32 vcc, 0, v238
    s_cbranch_vccnz SLOW_19
BACK_20:
    v_exp_f32 v238, v238
    s_nop 0
    v_cvt_pk_bf16_f32 v239, v238, v238
    v_and_b32 v228, v239, v232
    v_and_b32 v229, v239, v233
    v_and_b32 v230, v239, v234
    v_and_b32 v231, v239, v235
    v_add_f32 v237, v237, v238
    s_nop 0
    v_mfma_f32_16x16x32_bf16 v[208:211], v[228:231], v[160:163], v[208:211]
    v_mfma_f32_16x16x32_bf16 v[212:215], v[228:231], v[164:167], v[212:215]
    v_mfma_f32_16x16x32_bf16 v[220:223], v[184:187], v[200:203], 0
    v_mfma_f32_16x16x32_bf16 v[220:223], v[188:191], v[204:207], v[220:223]
    v_mov_b32_dpp v239, v216 quad_perm:[0,0,0,0] row_mask:0xf bank_mask:0xf
    v_mov_b32_dpp v240, v218 quad_perm:[2,2,2,2] row_mask:0xf bank_mask:0xf
    s_nop 0
    v_add_f32_dpp v239, v217, v239 quad_perm:[1,1,1,1] row_mask:0xf bank_mask:0xf
    v_add_f32_dpp v240, v219, v240 quad_perm:[3,3,3,3] row_mask:0xf bank_mask:0xf
    v_add_f32 v239, v239, v240
    v_cvt_pk_bf16_f32 v239, v239, v239
    v_and_b32 v241, 0xffff0000, v239
    v_fma_f32 v238, v241, s14, -v236
    v_cmp_lt_f32 vcc, 0, v238
    s_cbranch_vccnz SLOW_21
BACK_22:
    v_exp_f32 v238, v238
    s_nop 0
    v_cvt_pk_bf16_f32 v239, v238, v238
    v_and_b32 v224, v239, v232
    v_and_b32 v225, v239, v233
    v_and_b32 v226, v239, v234
    v_and_b32 v227, v239, v235
    v_add_f32 v237, v237, v238
    s_nop 0
    v_mfma_f32_16x16x32_bf16 v[208:211], v[224:227], v[176:179], v[208:211]
    v_mfma_f32_16x16x32_bf16 v[212:215], v[224:227], v[180:183], v[212:215]
    v_mov_b32_dpp v239, v220 quad_perm:[0,0,0,0] row_mask:0xf bank_mask:0xf
    v_mov_b32_dpp v240, v222 quad_perm:[2,2,2,2] row_mask:0xf bank_mask:0xf
    s_nop 0
    v_add_f32_dpp v239, v221, v239 quad_perm:[1,1,1,1] row_mask:0xf bank_mask:0xf
    v_add_f32_dpp v240, v223, v240 quad_perm:[3,3,3,3] row_mask:0xf bank_mask:0xf
    v_add_f32 v239, v239, v240
    v_cvt_pk_bf16_f32 v239, v239, v239
    v_and_b32 v241, 0xffff0000, v239
    v_fma_f32 v238, v241, s14, -v236
    v_cmp_lt_f32 vcc, 0, v238
    s_cbranch_vccnz SLOW_23
BACK_24:
    v_exp_f32 v238, v238
    s_nop 0
    v_cvt_pk_bf16_f32 v239, v238, v238
    v_and_b32 v228, v239, v232
    v_and_b32 v229, v239, v233
    v_and_b32 v230, v239, v234
    v_and_b32 v231, v239, v235
    v_add_f32 v237, v237, v238
    s_nop 0
    v_mfma_f32_16x16x32_bf16 v[208:211], v[228:231], v[192:195], v[208:211]
    v_mfma_f32_16x16x32_bf16 v[212:215], v[228:231], v[196:199], v[212:215]
    v_mfma_f32_16x16x32_bf16 v[216:219], v[8:11], v[200:203], 0
    v_mfma_f32_16x16x32_bf16 v[216:219], v[12:15], v[204:207], v[216:219]
    s_nop 7
    v_mov_b32_dpp v239, v216 quad_perm:[0,0,0,0] row_mask:0xf bank_mask:0xf
    v_mov_b32_dpp v240, v218 quad_perm:[2,2,2,2] row_mask:0xf bank_mask:0xf
    s_nop 0
    v_add_f32_dpp v239, v217, v239 quad_perm:[1,1,1,1] row_mask:0xf bank_mask:0xf
    v_add_f32_dpp v240, v219, v240 quad_perm:[3,3,3,3] row_mask:0xf bank_mask:0xf
    v_add_f32 v239, v239, v240
    v_cvt_pk_bf16_f32 v239, v239, v239
    v_and_b32 v241, 0xffff0000, v239
    v_fma_f32 v238, v241, s14, -v236
    v_cmp_lt_f32 vcc, 0, v238
    s_cbranch_vccnz SLOW_25
BACK_26:
    v_exp_f32 v238, v238
    s_nop 0
    v_cvt_pk_bf16_f32 v239, v238, v238
    v_and_b32 v224, v239, v232
    v_and_b32 v225, v239, v233
    v_and_b32 v226, v239, v234
    v_and_b32 v227, v239, v235
    v_add_f32 v237, v237, v238
    v_mul_u32_u24 v104, 3584, v5
    v_lshl_add_u32 v104, v4, 4, v104
    s_lshl_b32 s6, s4, 5
    s_add_u32 s6, s6, s3
    s_mul_i32 s6, s6, 14336
    s_add_u32 s68, s24, s6
    s_addc_u32 s69, s25, 0
    s_sub_u32 s70, 3670016, s6
    s_mov_b32 s71, 0x00020000
    v_and_b32 v105, 1, v5
    v_lshlrev_b32 v105, 13, v105
    v_lshl_add_u32 v105, v4, 4, v105
    s_lshl_b32 s6, s4, 2
    s_add_u32 s6, s6, s3
    s_lshl_b32 s6, s6, 14
    s_lshl_b32 s7, s5, 8
    s_add_u32 s6, s6, s7
    s_add_u32 s6, s6, 1048576
    v_add_u32 v105, s6, v105
    s_lshl_b32 s6, s3, 9
    v_and_b32 v106, 31, v0
    v_lshlrev_b32 v106, 4, v106
    v_add_u32 v106, s6, v106
    v_add_u32 v113, 10624, v106
    s_lshl_b32 s7, s4, 14
    s_add_u32 s7, s7, 524288
    v_add_u32 v114, s7, v106
    v_add_u32 v106, 1024, v106
    s_lshr_b32 s6, s3, 1
    s_lshl_b32 s6, s6, 6
    s_add_u32 s6, s6, 9216
    v_mov_b32 v107, s6
    v_and_b32 v108, 3, v0
    v_lshlrev_b32 v108, 1, v108
    v_lshlrev_b32 v111, 1, v5
    s_lshl_b32 s6, s4, 16
    s_lshl_b32 s7, s3, 6
    s_add_u32 s6, s6, s7
    s_add_u32 s6, s6, 1048576
    v_lshlrev_b32 v109, 8, v4
    v_lshl_add_u32 v109, v5, 4, v109
    v_add_u32 v109, s6, v109
    s_lshl_b32 s6, s3, 11
    s_add_u32 s6, s6, 10624
    v_lshlrev_b32 v112, 5, v4
    v_lshl_add_u32 v112, v5, 4, v112
    v_add_u32 v112, s6, v112
    v_lshrrev_b32 v115, 3, v4
    v_lshlrev_b32 v115, 6, v115
    s_lshl_b32 s6, s3, 3
    s_add_u32 s6, s6, 9216
    v_add_u32 v115, s6, v115
    v_mov_b32 v116, 9248
    v_mov_b32 v117, 1
    s_mov_b32 s57, 0xffffff00
    s_mov_b32 s72, 0xfffffc00
    s_mov_b32 s74, 0x0c0c0501
    s_mov_b32 s75, 0x05010c0c
    s_mov_b32 s76, 0x03030303
    s_cmp_eq_u32 s3, 3
    s_cselect_b32 s77, 0xffff, -1
    s_mov_b32 s78, 0x0c0c0400
    s_mov_b32 s79, 0x0c0c0500
    s_mov_b32 s80, 0x0c0c0600
    s_mov_b32 s81, 0x0c0c0700
    s_mov_b32 s15, 0
    s_mov_b32 s82, 0
L_top:
    s_waitcnt vmcnt(4)
    buffer_load_dwordx4 v[8:11], v1, s[44:47], s8 offen offset:0 nt
    buffer_load_dwordx4 v[12:15], v1, s[44:47], s8 offen offset:256 nt
    v_mfma_f32_16x16x32_bf16 v[208:211], v[224:227], v[16:19], v[208:211]
    v_mfma_f32_16x16x32_bf16 v[212:215], v[224:227], v[20:23], v[212:215]
    s_sub_u32 s10, s10, 1
    s_waitcnt vmcnt(4)
    buffer_load_dwordx4 v[16:19], v2, s[48:51], s8 offen offset:0 nt
    buffer_load_dwordx4 v[20:23], v2, s[48:51], s8 offen offset:256 nt
    v_add_u32 v247, 1, v247
    ds_write_b32 v248, v247
    s_cmp_lg_u32 s10, 0
    s_cbranch_scc1 L_nt0
    s_mov_b64 exec, 1
    ds_add_rtn_u32 v244, v245, v246
    s_mov_b64 exec, -1
L_nt0:
    v_mfma_f32_16x16x32_bf16 v[216:219], v[24:27], v[200:203], 0
    v_mfma_f32_16x16x32_bf16 v[216:219], v[28:31], v[204:207], v[216:219]
    s_nop 7
    v_mov_b32_dpp v239, v216 quad_perm:[0,0,0,0] row_mask:0xf bank_mask:0xf
    v_mov_b32_dpp v240, v218 quad_perm:[2,2,2,2] row_mask:0xf bank_mask:0xf
    s_nop 0
    v_add_f32_dpp v239, v217, v239 quad_perm:[1,1,1,1] row_mask:0xf bank_mask:0xf
    v_add_f32_dpp v240, v219, v240 quad_perm:[3,3,3,3] row_mask:0xf bank_mask:0xf
    v_add_f32 v239, v239, v240
    v_cvt_pk_bf16_f32 v239, v239, v239
    v_and_b32 v241, 0xffff0000, v239
    v_fma_f32 v238, v241, s14, -v236
    v_cmp_lt_f32 vcc, 0, v238
    s_cbranch_vccnz SLOW_27
BACK_28:
    v_exp_f32 v238, v238
    s_nop 0
    v_cvt_pk_bf16_f32 v239, v238, v238
    v_and_b32 v224, v239, v232
    v_and_b32 v225, v239, v233
    v_and_b32 v226, v239, v234
    v_and_b32 v227, v239, v235
    v_add_f32 v237, v237, v238
    s_cmp_eq_u32 s10, 0
    s_cbranch_scc1 L_hd0
L_bk0:
    s_add_u32 s9, s9, 0x800
    s_and_b32 s9, s9, 0x1fff
    s_add_u32 s8, s52, s9
    s_waitcnt vmcnt(4)
    buffer_load_dwordx4 v[24:27], v1, s[44:47], s8 offen offset:0 nt
    buffer_load_dwordx4 v[28:31], v1, s[44:47], s8 offen offset:256 nt
    v_mfma_f32_16x16x32_bf16 v[208:211], v[224:227], v[32:35], v[208:211]
    v_mfma_f32_16x16x32_bf16 v[212:215], v[224:227], v[36:39], v[212:215]
    s_sub_u32 s10, s10, 1
    s_waitcnt vmcnt(4)
    buffer_load_dwordx4 v[32:35], v2, s[48:51], s8 offen offset:0 nt
    buffer_load_dwordx4 v[36:39], v2, s[48:51], s8 offen offset:256 nt
    v_add_u32 v247, 1, v247
    ds_write_b32 v248, v247
    s_cmp_lg_u32 s10, 0
    s_cbranch_scc1 L_nt1
    s_mov_b64 exec, 1
    ds_add_rtn_u32 v244, v245, v246
    s_mov_b64 exec, -1
L_nt1:
    v_mfma_f32_16x16x32_bf16 v[216:219], v[8:11], v[200:203], 0
    v_mfma_f32_16x16x32_bf16 v[216:219], v[12:15], v[204:207], v[216:219]
    s_nop 7
    v_mov_b32_dpp v239, v216 quad_perm:[0,0,0,0] row_mask:0xf bank_mask:0xf
    v_mov_b32_dpp v240, v218 quad_perm:[2,2,2,2] row_mask:0xf bank_mask:0xf
    s_nop 0
    v_add_f32_dpp v239, v217, v239 quad_perm:[1,1,1,1] row_mask:0xf bank_mask:0xf
    v_add_f32_dpp v240, v219, v240 quad_perm:[3,3,3,3] row_mask:0xf bank_mask:0xf
    v_add_f32 v239, v239, v240
    v_cvt_pk_bf16_f32 v239, v239, v239
    v_and_b32 v241, 0xffff0000, v239
    v_fma_f32 v238, v241, s14, -v236
    v_cmp_lt_f32 vcc, 0, v238
    s_cbranch_vccnz SLOW_29
BACK_30:
    v_exp_f32 v238, v238
    s_nop 0
    v_cvt_pk_bf16_f32 v239, v238, v238
    v_and_b32 v224, v239, v232
    v_and_b32 v225, v239, v233
    v_and_b32 v226, v239, v234
    v_and_b32 v227, v239, v235
    v_add_f32 v237, v237, v238
    s_cmp_eq_u32 s10, 0
    s_cbranch_scc1 L_hd1
L_bk1:
    s_add_u32 s9, s9, 0x800
    s_and_b32 s9, s9, 0x1fff
    s_add_u32 s8, s52, s9
    s_branch L_top
L_hd0:
    s_waitcnt lgkmcnt(0)
    v_readfirstlane_b32 s6, v244
L_hc0:
    s_cmp_ge_u32 s6, s53
    s_cbranch_scc1 L_nm0
    s_add_u32 s7, s6, s54
    s_lshr_b32 s61, s7, 15
    s_mul_i32 s62, s61, s56
    s_lshr_b32 s62, s62, 16
    s_mul_i32 s63, s62, s65
    s_sub_u32 s61, s61, s63
    s_lshl_b32 s61, s61, 20
    s_lshl_b32 s62, s62, 15
    s_and_b32 s7, s7, 0x7fff
    s_add_u32 s52, s61, s62
    s_add_u32 s52, s52, s7
    s_add_u32 s52, s52, s64
    s_mov_b32 s10, s58
    s_or_b32 s9, s9, s60
    s_branch L_bk0
L_nm0:
    s_cmp_eq_u32 s11, 5
    s_cbranch_scc1 L_drain0
    s_cmp_eq_u32 s11, 4
    s_cbranch_scc1 L_m20
L_pw0:
    ds_read_b128 v[220:223], v6 offset:32
    ds_read_b128 v[228:231], v6 offset:48
    s_add_u32 s59, s59, 1
    s_waitcnt lgkmcnt(0)
    v_readfirstlane_b32 s53, v220
    v_readfirstlane_b32 s54, v221
    v_readfirstlane_b32 s56, v222
    v_readfirstlane_b32 s65, v223
    v_readfirstlane_b32 s64, v228
    v_readfirstlane_b32 s66, v229
    v_readfirstlane_b32 s67, v230
    s_cmp_ge_u32 s59, 1048576
    s_cbranch_scc1 L_drain0
    s_cmp_eq_u32 s53, 0
    s_cbranch_scc1 L_pw0
    v_add_u32 v6, 32, v6
    s_add_u32 s11, s11, 1
    s_branch L_hc0
L_m20:
    v_mov_b32 v245, 9352
    v_mov_b32 v246, 0x800
    s_mov_b64 exec, 1
    ds_add_rtn_u32 v244, v245, v246
    s_mov_b64 exec, -1
    s_mov_b32 s53, s66
    s_mov_b32 s54, s67
    s_mov_b32 s58, 1
    s_mov_b32 s60, 0x1800
    s_mov_b32 s11, 5
    s_branch L_hd0
L_hd1:
    s_waitcnt lgkmcnt(0)
    v_readfirstlane_b32 s6, v244
L_hc1:
    s_cmp_ge_u32 s6, s53
    s_cbranch_scc1 L_nm1
    s_add_u32 s7, s6, s54
    s_lshr_b32 s61, s7, 15
    s_mul_i32 s62, s61, s56
    s_lshr_b32 s62, s62, 16
    s_mul_i32 s63, s62, s65
    s_sub_u32 s61, s61, s63
    s_lshl_b32 s61, s61, 20
    s_lshl_b32 s62, s62, 15
    s_and_b32 s7, s7, 0x7fff
    s_add_u32 s52, s61, s62
    s_add_u32 s52, s52, s7
    s_add_u32 s52, s52, s64
    s_mov_b32 s10, s58
    s_or_b32 s9, s9, s60
    s_branch L_bk1
L_nm1:
    s_cmp_eq_u32 s11, 5
    s_cbranch_scc1 L_drain1
    s_cmp_eq_u32 s11, 4
    s_cbranch_scc1 L_m21
L_pw1:
    ds_read_b128 v[220:223], v6 offset:32
    ds_read_b128 v[228:231], v6 offset:48
    s_add_u32 s59, s59, 1
    s_waitcnt lgkmcnt(0)
    v_readfirstlane_b32 s53, v220
    v_readfirstlane_b32 s54, v221
    v_readfirstlane_b32 s56, v222
    v_readfirstlane_b32 s65, v223
    v_readfirstlane_b32 s64, v228
    v_readfirstlane_b32 s66, v229
    v_readfirstlane_b32 s67, v230
    s_cmp_ge_u32 s59, 1048576
    s_cbranch_scc1 L_drain1
    s_cmp_eq_u32 s53, 0
    s_cbranch_scc1 L_pw1
    v_add_u32 v6, 32, v6
    s_add_u32 s11, s11, 1
    s_branch L_hc1
L_m21:
    v_mov_b32 v245, 9352
    v_mov_b32 v246, 0x800
    s_mov_b64 exec, 1
    ds_add_rtn_u32 v244, v245, v246
    s_mov_b64 exec, -1
    s_mov_b32 s53, s66
    s_mov_b32 s54, s67
    s_mov_b32 s58, 1
    s_mov_b32 s60, 0x1800
    s_mov_b32 s11, 5
    s_branch L_hd1
L_drain0:
    ds_read_b32 v244, v116 offset:108
    s_waitcnt lgkmcnt(0)
    v_readfirstlane_b32 s6, v244
    s_sub_u32 s6, s6, 1
    s_cmp_lt_u32 s6, 8
    s_cbranch_scc1 L_drainw0
    s_waitcnt vmcnt(4)
    v_mfma_f32_16x16x32_bf16 v[208:211], v[224:227], v[32:35], v[208:211]
    v_mfma_f32_16x16x32_bf16 v[212:215], v[224:227], v[36:39], v[212:215]
    ds_read_b64 v[118:119], v116
    s_waitcnt vmcnt(2)
    v_mfma_f32_16x16x32_bf16 v[216:219], v[8:11], v[200:203], 0
    v_mfma_f32_16x16x32_bf16 v[216:219], v[12:15], v[204:207], v[216:219]
    s_nop 7
    v_mov_b32_dpp v239, v216 quad_perm:[0,0,0,0] row_mask:0xf bank_mask:0xf
    v_mov_b32_dpp v240, v218 quad_perm:[2,2,2,2] row_mask:0xf bank_mask:0xf
    s_nop 0
    v_add_f32_dpp v239, v217, v239 quad_perm:[1,1,1,1] row_mask:0xf bank_mask:0xf
    v_add_f32_dpp v240, v219, v240 quad_perm:[3,3,3,3] row_mask:0xf bank_mask:0xf
    v_add_f32 v239, v239, v240
    v_cvt_pk_bf16_f32 v239, v239, v239
    v_and_b32 v241, 0xffff0000, v239
    v_fma_f32 v238, v241, s14, -v236
    v_cmp_lt_f32 vcc, 0, v238
    s_cbranch_vccnz SLOW_31
BACK_32:
    v_exp_f32 v238, v238
    s_nop 0
    v_cvt_pk_bf16_f32 v239, v238, v238
    v_and_b32 v224, v239, v232
    v_and_b32 v225, v239, v233
    v_and_b32 v226, v239, v234
    v_and_b32 v227, v239, v235
    v_add_f32 v237, v237, v238
    v_mov_b32 v240, v237
    s_nop 1
    v_permlane16_swap_b32 v237, v240
    v_add_f32 v237, v237, v240
    v_mov_b32 v240, v237
    s_nop 1
    v_permlane32_swap_b32 v237, v240
    v_add_f32 v237, v237, v240
    s_mov_b64 exec, 0x101
    ds_write_b64 v115, v[236:237]
    s_mov_b64 exec, -1
    s_waitcnt vmcnt(1)
    v_mfma_f32_16x16x32_bf16 v[208:211], v[224:227], v[16:19], v[208:211]
    s_waitcnt vmcnt(0)
    v_mfma_f32_16x16x32_bf16 v[212:215], v[224:227], v[20:23], v[212:215]
    s_branch L_fin
L_drainw0:
    s_mul_i32 s73, s6, 57344
    s_mov_b32 s82, 1
    s_waitcnt vmcnt(4)
    v_mfma_f32_16x16x32_bf16 v[208:211], v[224:227], v[32:35], v[208:211]
    v_mfma_f32_16x16x32_bf16 v[212:215], v[224:227], v[36:39], v[212:215]
    buffer_load_dwordx4 v[40:43], v104, s[68:71], s73 offen offset:0 nt
    buffer_load_dwordx4 v[44:47], v104, s[68:71], s73 offen offset:256 nt
    buffer_load_dwordx4 v[48:51], v104, s[68:71], s73 offen offset:512 nt
    buffer_load_dwordx4 v[56:59], v104, s[68:71], s73 offen offset:896 nt
    ds_read_b64 v[118:119], v116
    s_waitcnt vmcnt(6)
    v_mfma_f32_16x16x32_bf16 v[216:219], v[8:11], v[200:203], 0
    v_mfma_f32_16x16x32_bf16 v[216:219], v[12:15], v[204:207], v[216:219]
    s_nop 7
    v_mov_b32_dpp v239, v216 quad_perm:[0,0,0,0] row_mask:0xf bank_mask:0xf
    v_mov_b32_dpp v240, v218 quad_perm:[2,2,2,2] row_mask:0xf bank_mask:0xf
    s_nop 0
    v_add_f32_dpp v239, v217, v239 quad_perm:[1,1,1,1] row_mask:0xf bank_mask:0xf
    v_add_f32_dpp v240, v219, v240 quad_perm:[3,3,3,3] row_mask:0xf bank_mask:0xf
    v_add_f32 v239, v239, v240
    v_cvt_pk_bf16_f32 v239, v239, v239
    v_and_b32 v241, 0xffff0000, v239
    v_fma_f32 v238, v241, s14, -v236
    v_cmp_lt_f32 vcc, 0, v238
    s_cbranch_vccnz SLOW_33
BACK_34:
    v_exp_f32 v238, v238
    s_nop 0
    v_cvt_pk_bf16_f32 v239, v238, v238
    v_and_b32 v224, v239, v232
    v_and_b32 v225, v239, v233
    v_and_b32 v226, v239, v234
    v_and_b32 v227, v239, v235
    v_add_f32 v237, v237, v238
    v_mov_b32 v240, v237
    s_nop 1
    v_permlane16_swap_b32 v237, v240
    v_add_f32 v237, v237, v240
    v_mov_b32 v240, v237
    s_nop 1
    v_permlane32_swap_b32 v237, v240
    v_add_f32 v237, v237, v240
    s_mov_b64 exec, 0x101
    ds_write_b64 v115, v[236:237]
    s_mov_b64 exec, -1
    s_waitcnt vmcnt(5)
    v_mfma_f32_16x16x32_bf16 v[208:211], v[224:227], v[16:19], v[208:211]
    s_waitcnt vmcnt(4)
    v_mfma_f32_16x16x32_bf16 v[212:215], v[224:227], v[20:23], v[212:215]
    s_branch L_fin
L_drain1:
    ds_read_b32 v244, v116 offset:108
    s_waitcnt lgkmcnt(0)
    v_readfirstlane_b32 s6, v244
    s_sub_u32 s6, s6, 1
    s_cmp_lt_u32 s6, 8
    s_cbranch_scc1 L_drainw1
    s_waitcnt vmcnt(4)
    v_mfma_f32_16x16x32_bf16 v[208:211], v[224:227], v[16:19], v[208:211]
    v_mfma_f32_16x16x32_bf16 v[212:215], v[224:227], v[20:23], v[212:215]
    ds_read_b64 v[118:119], v116
    s_waitcnt vmcnt(2)
    v_mfma_f32_16x16x32_bf16 v[216:219], v[24:27], v[200:203], 0
    v_mfma_f32_16x16x32_bf16 v[216:219], v[28:31], v[204:207], v[216:219]
    s_nop 7
    v_mov_b32_dpp v239, v216 quad_perm:[0,0,0,0] row_mask:0xf bank_mask:0xf
    v_mov_b32_dpp v240, v218 quad_perm:[2,2,2,2] row_mask:0xf bank_mask:0xf
    s_nop 0
    v_add_f32_dpp v239, v217, v239 quad_perm:[1,1,1,1] row_mask:0xf bank_mask:0xf
    v_add_f32_dpp v240, v219, v240 quad_perm:[3,3,3,3] row_mask:0xf bank_mask:0xf
    v_add_f32 v239, v239, v240
    v_cvt_pk_bf16_f32 v239, v239, v239
    v_and_b32 v241, 0xffff0000, v239
    v_fma_f32 v238, v241, s14, -v236
    v_cmp_lt_f32 vcc, 0, v238
    s_cbranch_vccnz SLOW_35
BACK_36:
    v_exp_f32 v238, v238
    s_nop 0
    v_cvt_pk_bf16_f32 v239, v238, v238
    v_and_b32 v224, v239, v232
    v_and_b32 v225, v239, v233
    v_and_b32 v226, v239, v234
    v_and_b32 v227, v239, v235
    v_add_f32 v237, v237, v238
    v_mov_b32 v240, v237
    s_nop 1
    v_permlane16_swap_b32 v237, v240
    v_add_f32 v237, v237, v240
    v_mov_b32 v240, v237
    s_nop 1
    v_permlane32_swap_b32 v237, v240
    v_add_f32 v237, v237, v240
    s_mov_b64 exec, 0x101
    ds_write_b64 v115, v[236:237]
    s_mov_b64 exec, -1
    s_waitcnt vmcnt(1)
    v_mfma_f32_16x16x32_bf16 v[208:211], v[224:227], v[32:35], v[208:211]
    s_waitcnt vmcnt(0)
    v_mfma_f32_16x16x32_bf16 v[212:215], v[224:227], v[36:39], v[212:215]
    s_branch L_fin
L_drainw1:
    s_mul_i32 s73, s6, 57344
    s_mov_b32 s82, 1
    s_waitcnt vmcnt(4)
    v_mfma_f32_16x16x32_bf16 v[208:211], v[224:227], v[16:19], v[208:211]
    v_mfma_f32_16x16x32_bf16 v[212:215], v[224:227], v[20:23], v[212:215]
    buffer_load_dwordx4 v[40:43], v104, s[68:71], s73 offen offset:0 nt
    buffer_load_dwordx4 v[44:47], v104, s[68:71], s73 offen offset:256 nt
    buffer_load_dwordx4 v[48:51], v104, s[68:71], s73 offen offset:512 nt
    buffer_load_dwordx4 v[56:59], v104, s[68:71], s73 offen offset:896 nt
    ds_read_b64 v[118:119], v116
    s_waitcnt vmcnt(6)
    v_mfma_f32_16x16x32_bf16 v[216:219], v[24:27], v[200:203], 0
    v_mfma_f32_16x16x32_bf16 v[216:219], v[28:31], v[204:207], v[216:219]
    s_nop 7
    v_mov_b32_dpp v239, v216 quad_perm:[0,0,0,0] row_mask:0xf bank_mask:0xf
    v_mov_b32_dpp v240, v218 quad_perm:[2,2,2,2] row_mask:0xf bank_mask:0xf
    s_nop 0
    v_add_f32_dpp v239, v217, v239 quad_perm:[1,1,1,1] row_mask:0xf bank_mask:0xf
    v_add_f32_dpp v240, v219, v240 quad_perm:[3,3,3,3] row_mask:0xf bank_mask:0xf
    v_add_f32 v239, v239, v240
    v_cvt_pk_bf16_f32 v239, v239, v239
    v_and_b32 v241, 0xffff0000, v239
    v_fma_f32 v238, v241, s14, -v236
    v_cmp_lt_f32 vcc, 0, v238
    s_cbranch_vccnz SLOW_37
BACK_38:
    v_exp_f32 v238, v238
    s_nop 0
    v_cvt_pk_bf16_f32 v239, v238, v238
    v_and_b32 v224, v239, v232
    v_and_b32 v225, v239, v233
    v_and_b32 v226, v239, v234
    v_and_b32 v227, v239, v235
    v_add_f32 v237, v237, v238
    v_mov_b32 v240, v237
    s_nop 1
    v_permlane16_swap_b32 v237, v240
    v_add_f32 v237, v237, v240
    v_mov_b32 v240, v237
    s_nop 1
    v_permlane32_swap_b32 v237, v240
    v_add_f32 v237, v237, v240
    s_mov_b64 exec, 0x101
    ds_write_b64 v115, v[236:237]
    s_mov_b64 exec, -1
    s_waitcnt vmcnt(5)
    v_mfma_f32_16x16x32_bf16 v[208:211], v[224:227], v[32:35], v[208:211]
    s_waitcnt vmcnt(4)
    v_mfma_f32_16x16x32_bf16 v[212:215], v[224:227], v[36:39], v[212:215]
    s_branch L_fin
L_fin:
    s_nop 5
    ds_write_b128 v3, v[208:211]
    ds_write_b128 v3, v[212:215] offset:512
    s_waitcnt lgkmcnt(0)
    s_barrier
    s_mov_b32 exec_hi, 0
    ds_read_b128 v[8:11], v107 offset:0
    ds_read_b128 v[12:15], v107 offset:16
    ds_read_b128 v[16:19], v106 offset:0
    ds_read_b128 v[20:23], v106 offset:2048
    ds_read_b128 v[24:27], v106 offset:4096
    ds_read_b128 v[28:31], v106 offset:6144
    s_waitcnt lgkmcnt(4)
    v_max3_f32 v32, v8, v10, v12
    v_max_f32 v32, v32, v14
    v_sub_f32 v8, v8, v32
    v_sub_f32 v10, v10, v32
    v_sub_f32 v12, v12, v32
    v_sub_f32 v14, v14, v32
    v_exp_f32 v8, v8
    v_exp_f32 v10, v10
    v_exp_f32 v12, v12
    v_exp_f32 v14, v14
    v_mul_f32 v33, v8, v9
    v_fma_f32 v33, v10, v11, v33
    v_fma_f32 v33, v12, v13, v33
    v_fma_f32 v33, v14, v15, v33
    v_log_f32 v36, v33
    v_rcp_f32 v34, v33
    s_waitcnt lgkmcnt(0)
    v_pk_mul_f32 v[152:153], v[16:17], v[8:9] op_sel_hi:[1,0]
    v_pk_mul_f32 v[154:155], v[18:19], v[8:9] op_sel_hi:[1,0]
    v_add_f32 v36, v36, v32
    v_pk_fma_f32 v[152:153], v[20:21], v[10:11], v[152:153] op_sel_hi:[1,0,1]
    v_pk_fma_f32 v[154:155], v[22:23], v[10:11], v[154:155] op_sel_hi:[1,0,1]
    v_lshrrev_b32 v36, v108, v36
    v_pk_fma_f32 v[152:153], v[24:25], v[12:13], v[152:153] op_sel_hi:[1,0,1]
    v_pk_fma_f32 v[154:155], v[26:27], v[12:13], v[154:155] op_sel_hi:[1,0,1]
    v_and_b32 v36, s76, v36
    v_pk_fma_f32 v[152:153], v[28:29], v[14:15], v[152:153] op_sel_hi:[1,0,1]
    v_pk_fma_f32 v[154:155], v[30:31], v[14:15], v[154:155] op_sel_hi:[1,0,1]
    v_perm_b32 v156, v36, v118, s78
    v_perm_b32 v157, v36, v118, s79
    v_perm_b32 v158, v36, v118, s80
    v_perm_b32 v159, v36, v118, s81
    v_pk_mul_f32 v[152:153], v[152:153], v[34:35] op_sel_hi:[1,0]
    v_pk_mul_f32 v[154:155], v[154:155], v[34:35] op_sel_hi:[1,0]
    v_and_or_b32 v36, v152, s72, v156
    v_and_or_b32 v37, v153, s72, v157
    v_and_or_b32 v38, v154, s72, v158
    v_and_or_b32 v39, v155, s72, v159
    global_store_dwordx4 v105, v[36:39], s[40:41] sc1
    s_mov_b32 exec_hi, -1
L_tk:
    ds_read_b32 v8, v116 offset:108
    s_add_u32 s15, s15, 1
    s_waitcnt lgkmcnt(0)
    v_readfirstlane_b32 s6, v8
    s_cmp_ge_u32 s15, 1048576
    s_cbranch_scc1 L_end
    s_cmp_eq_u32 s6, 0
    s_cbranch_scc1 L_tk
    s_sub_u32 s6, s6, 1
    s_mov_b32 s15, 0
    s_cmp_ge_u32 s6, 8
    s_cbranch_scc1 L_end
    s_mul_i32 s73, s6, 57344
    s_cmp_eq_u32 s82, 1
    s_cbranch_scc1 L_wowd
    buffer_load_dwordx4 v[40:43], v104, s[68:71], s73 offen offset:0 nt
    buffer_load_dwordx4 v[44:47], v104, s[68:71], s73 offen offset:256 nt
    buffer_load_dwordx4 v[48:51], v104, s[68:71], s73 offen offset:512 nt
    buffer_load_dwordx4 v[56:59], v104, s[68:71], s73 offen offset:896 nt
L_wowd:
    buffer_load_dwordx4 v[60:63], v104, s[68:71], s73 offen offset:1152 nt
    buffer_load_dwordx4 v[64:67], v104, s[68:71], s73 offen offset:1408 nt
    buffer_load_dwordx4 v[72:75], v104, s[68:71], s73 offen offset:1792 nt
    buffer_load_dwordx4 v[76:79], v104, s[68:71], s73 offen offset:2048 nt
    buffer_load_dwordx4 v[80:83], v104, s[68:71], s73 offen offset:2304 nt
    buffer_load_dwordx4 v[88:91], v104, s[68:71], s73 offen offset:2688 nt
    buffer_load_dwordx4 v[92:95], v104, s[68:71], s73 offen offset:2944 nt
    buffer_load_dwordx4 v[96:99], v104, s[68:71], s73 offen offset:3200 nt
    s_mov_b32 exec_lo, 0x00ff00ff
    s_mov_b32 exec_hi, 0x00ff00ff
    buffer_load_dwordx4 v[52:55], v104, s[68:71], s73 offen offset:768 nt
    buffer_load_dwordx4 v[68:71], v104, s[68:71], s73 offen offset:1664 nt
    buffer_load_dwordx4 v[84:87], v104, s[68:71], s73 offen offset:2560 nt
    buffer_load_dwordx4 v[100:103], v104, s[68:71], s73 offen offset:3456 nt
    s_mov_b64 exec, -1
    s_lshl_b32 s7, s6, 13
    v_add_u32 v109, s7, v109
    v_add_u32 v110, 4096, v109
    s_lshl_b32 s7, s6, 11
    v_add_u32 v114, s7, v114
L_pollP:
    global_load_dwordx4 v[8:11], v109, s[40:41] sc1
    global_load_dwordx4 v[12:15], v110, s[40:41] sc1
    s_waitcnt vmcnt(0)
    v_msad_u8 v24, v8, v118, 0
    v_msad_u8 v25, v9, v118, 0
    v_msad_u8 v24, v10, v118, v24
    v_msad_u8 v25, v11, v118, v25
    v_msad_u8 v24, v12, v118, v24
    v_msad_u8 v25, v13, v118, v25
    v_msad_u8 v24, v14, v118, v24
    v_msad_u8 v25, v15, v118, v25
    v_or_b32 v24, v24, v25
    v_cmp_ne_u32 vcc, 0, v24
    v_perm_b32 v16, v9, v8, s74
    v_perm_b32 v17, v11, v10, s75
    v_perm_b32 v18, v13, v12, s74
    v_perm_b32 v19, v15, v14, s75
    s_add_u32 s15, s15, 1
    s_cmp_ge_u32 s15, 65536
    s_cbranch_scc1 L_pollP_done
    s_and_b64 exec, exec, vcc
    s_cbranch_scc0 L_pollP_done
    s_branch L_pollP
L_pollP_done:
    s_mov_b64 exec, -1
    v_or_b32 v16, v16, v17
    v_or_b32 v18, v18, v19
    v_and_b32 v16, s76, v16
    v_and_b32 v18, s76, v18
    v_lshlrev_b32 v16, v111, v16
    v_lshlrev_b32 v18, v111, v18
    s_nop 1
    v_permlane16_swap_b32 v16, v18
    v_or_b32 v16, v16, v18
    v_mov_b32 v17, v16
    s_nop 1
    v_permlane32_swap_b32 v16, v17
    v_or_b32 v16, v16, v17
    s_nop 1
    v_max_f32_dpp v17, v16, v16 quad_perm:[1,0,3,2] row_mask:0xf bank_mask:0xf
    s_nop 1
    v_max_f32_dpp v17, v17, v17 quad_perm:[2,3,0,1] row_mask:0xf bank_mask:0xf
    s_nop 1
    v_max_f32_dpp v17, v17, v17 row_half_mirror row_mask:0xf bank_mask:0xf
    s_nop 1
    v_max_f32_dpp v17, v17, v17 row_mirror row_mask:0xf bank_mask:0xf
    v_mov_b32 v18, v17
    s_nop 1
    v_permlane16_swap_b32 v17, v18
    v_max_f32 v17, v17, v18
    v_sub_f32 v16, v16, v17
    v_exp_f32 v16, v16
    s_nop 0
    v_mov_b32 v18, v16
    s_nop 1
    v_permlane16_swap_b32 v16, v18
    v_pk_mul_f32 v[20:21], v[8:9], v[16:17] op_sel_hi:[1,0]
    v_pk_mul_f32 v[22:23], v[10:11], v[16:17] op_sel_hi:[1,0]
    v_pk_fma_f32 v[20:21], v[12:13], v[18:19], v[20:21] op_sel_hi:[1,0,1]
    v_pk_fma_f32 v[22:23], v[14:15], v[18:19], v[22:23] op_sel_hi:[1,0,1]
    v_add_f32 v16, v16, v18
    v_add_f32_dpp v20, v20, v20 row_ror:8 row_mask:0xf bank_mask:0x3
    v_add_f32_dpp v21, v21, v21 row_ror:8 row_mask:0xf bank_mask:0x3
    s_nop 0
    v_add_f32_dpp v20, v22, v22 row_ror:8 row_mask:0xf bank_mask:0xc
    v_add_f32_dpp v21, v23, v23 row_ror:8 row_mask:0xf bank_mask:0xc
    s_nop 0
    v_add_f32_dpp v20, v20, v20 row_half_mirror row_mask:0xf bank_mask:0x5
    s_nop 1
    v_add_f32_dpp v20, v21, v21 row_half_mirror row_mask:0xf bank_mask:0xa
    s_nop 1
    v_add_f32_dpp v20, v20, v20 quad_perm:[1,0,3,2] row_mask:0xf bank_mask:0xf
    s_nop 1
    v_add_f32_dpp v20, v20, v20 quad_perm:[2,3,0,1] row_mask:0xf bank_mask:0xf
    v_cvt_pk_bf16_f32 v20, v20, v20
    s_nop 1
    v_and_b32_dpp v136, v20, v232 row_newbcast:0 row_mask:0xf bank_mask:0xf
    v_and_b32_dpp v137, v20, v233 row_newbcast:0 row_mask:0xf bank_mask:0xf
    v_and_b32_dpp v138, v20, v234 row_newbcast:0 row_mask:0xf bank_mask:0xf
    v_and_b32_dpp v139, v20, v235 row_newbcast:0 row_mask:0xf bank_mask:0xf
    s_nop 1
    v_mfma_f32_16x16x32_bf16 v[120:123], v[136:139], v[40:43], 0
    v_mfma_f32_16x16x32_bf16 v[124:127], v[136:139], v[44:47], 0
    v_mfma_f32_16x16x32_bf16 v[128:131], v[136:139], v[48:51], 0
    v_mfma_f32_16x16x32_bf16 v[132:135], v[136:139], v[52:55], 0
    v_and_b32_dpp v140, v20, v232 row_newbcast:4 row_mask:0xf bank_mask:0xf
    v_and_b32_dpp v141, v20, v233 row_newbcast:4 row_mask:0xf bank_mask:0xf
    v_and_b32_dpp v142, v20, v234 row_newbcast:4 row_mask:0xf bank_mask:0xf
    v_and_b32_dpp v143, v20, v235 row_newbcast:4 row_mask:0xf bank_mask:0xf
    s_nop 1
    v_mfma_f32_16x16x32_bf16 v[120:123], v[140:143], v[56:59], v[120:123]
    v_mfma_f32_16x16x32_bf16 v[124:127], v[140:143], v[60:63], v[124:127]
    v_mfma_f32_16x16x32_bf16 v[128:131], v[140:143], v[64:67], v[128:131]
    v_mfma_f32_16x16x32_bf16 v[132:135], v[140:143], v[68:71], v[132:135]
    v_and_b32_dpp v144, v20, v232 row_newbcast:8 row_mask:0xf bank_mask:0xf
    v_and_b32_dpp v145, v20, v233 row_newbcast:8 row_mask:0xf bank_mask:0xf
    v_and_b32_dpp v146, v20, v234 row_newbcast:8 row_mask:0xf bank_mask:0xf
    v_and_b32_dpp v147, v20, v235 row_newbcast:8 row_mask:0xf bank_mask:0xf
    s_nop 1
    v_mfma_f32_16x16x32_bf16 v[120:123], v[144:147], v[72:75], v[120:123]
    v_mfma_f32_16x16x32_bf16 v[124:127], v[144:147], v[76:79], v[124:127]
    v_mfma_f32_16x16x32_bf16 v[128:131], v[144:147], v[80:83], v[128:131]
    v_mfma_f32_16x16x32_bf16 v[132:135], v[144:147], v[84:87], v[132:135]
    v_and_b32_dpp v148, v20, v232 row_newbcast:12 row_mask:0xf bank_mask:0xf
    v_and_b32_dpp v149, v20, v233 row_newbcast:12 row_mask:0xf bank_mask:0xf
    v_and_b32_dpp v150, v20, v234 row_newbcast:12 row_mask:0xf bank_mask:0xf
    v_and_b32_dpp v151, v20, v235 row_newbcast:12 row_mask:0xf bank_mask:0xf
    s_nop 1
    v_mfma_f32_16x16x32_bf16 v[120:123], v[148:151], v[88:91], v[120:123]
    v_mfma_f32_16x16x32_bf16 v[124:127], v[148:151], v[92:95], v[124:127]
    v_mfma_f32_16x16x32_bf16 v[128:131], v[148:151], v[96:99], v[128:131]
    v_mfma_f32_16x16x32_bf16 v[132:135], v[148:151], v[100:103], v[132:135]
    s_mov_b32 exec_hi, 0
    s_nop 3
    ds_write_b128 v112, v[120:123] offset:0
    ds_write_b128 v112, v[124:127] offset:512
    ds_write_b128 v112, v[128:131] offset:1024
    ds_write_b128 v112, v[132:135] offset:1536
    s_mov_b32 exec_lo, 1
    ds_add_u32 v116, v117 offset:112
    s_mov_b32 exec_lo, -1
    s_mov_b32 s15, 0
    ds_read_b32 v17, v116 offset:112
    ds_read_b128 v[20:23], v113 offset:0
    ds_read_b128 v[24:27], v113 offset:2048
    ds_read_b128 v[28:31], v113 offset:4096
    ds_read_b128 v[32:35], v113 offset:6144
    v_add_f32_dpp v16, v16, v16 quad_perm:[1,0,3,2] row_mask:0xf bank_mask:0xf
    s_nop 1
    v_add_f32_dpp v16, v16, v16 quad_perm:[2,3,0,1] row_mask:0xf bank_mask:0xf
    s_nop 1
    v_add_f32_dpp v16, v16, v16 row_half_mirror row_mask:0xf bank_mask:0xf
    s_nop 1
    v_add_f32_dpp v16, v16, v16 row_mirror row_mask:0xf bank_mask:0xf
    v_rcp_f32 v16, v16
    s_nop 0
    v_mul_f32 v16, v16, v119
    s_branch L_red1
L_red:
    ds_read_b32 v17, v116 offset:112
    ds_read_b128 v[20:23], v113 offset:0
    ds_read_b128 v[24:27], v113 offset:2048
    ds_read_b128 v[28:31], v113 offset:4096
    ds_read_b128 v[32:35], v113 offset:6144
L_red1:
    s_add_u32 s15, s15, 1
    s_waitcnt lgkmcnt(4)
    v_readfirstlane_b32 s7, v17
    s_cmp_ge_u32 s15, 1048576
    s_cbranch_scc1 L_red2
    s_cmp_lt_u32 s7, 4
    s_cbranch_scc1 L_red
L_red2:
    s_mov_b32 exec_lo, s77
    s_waitcnt lgkmcnt(2)
    v_pk_add_f32 v[20:21], v[20:21], v[24:25]
    v_pk_add_f32 v[22:23], v[22:23], v[26:27]
    s_waitcnt lgkmcnt(0)
    v_pk_add_f32 v[28:29], v[28:29], v[32:33]
    v_pk_add_f32 v[30:31], v[30:31], v[34:35]
    v_pk_add_f32 v[20:21], v[20:21], v[28:29]
    v_pk_add_f32 v[22:23], v[22:23], v[30:31]
    v_pk_mul_f32 v[20:21], v[20:21], v[16:17] op_sel_hi:[1,0]
    v_pk_mul_f32 v[22:23], v[22:23], v[16:17] op_sel_hi:[1,0]
    v_and_or_b32 v20, v20, s57, v118
    v_and_or_b32 v21, v21, s57, v118
    v_and_or_b32 v22, v22, s57, v118
    v_and_or_b32 v23, v23, s57, v118
    global_store_dwordx4 v114, v[20:23], s[40:41] sc1
    s_endpgm
SLOW_1:
    s_nop 7
    v_mul_f32 v238, s14, v241
    v_max_f32 v239, v238, v236
    v_mov_b32 v240, v239
    s_nop 1
    v_permlane16_swap_b32 v239, v240
    v_max_f32 v239, v239, v240
    v_mov_b32 v240, v239
    s_nop 1
    v_permlane32_swap_b32 v239, v240
    v_max_f32 v239, v239, v240
    v_sub_f32 v240, v236, v239
    v_exp_f32 v240, v240
    v_mov_b32 v236, v239
    v_sub_f32 v238, v238, v239
    v_mul_f32 v237, v237, v240
    v_mov_b32_dpp v239, v240 row_ror:8 row_mask:0xf bank_mask:0xf
    v_cndmask_b32 v239, v239, v240, s[12:13]
    v_mul_f32 v208, v208, v239
    v_mul_f32 v209, v209, v239
    v_mul_f32 v210, v210, v239
    v_mul_f32 v211, v211, v239
    v_mul_f32 v212, v212, v239
    v_mul_f32 v213, v213, v239
    v_mul_f32 v214, v214, v239
    v_mul_f32 v215, v215, v239
    s_nop 1
    s_branch BACK_2
SLOW_3:
    s_nop 7
    v_mul_f32 v238, s14, v241
    v_max_f32 v239, v238, v236
    v_mov_b32 v240, v239
    s_nop 1
    v_permlane16_swap_b32 v239, v240
    v_max_f32 v239, v239, v240
    v_mov_b32 v240, v239
    s_nop 1
    v_permlane32_swap_b32 v239, v240
    v_max_f32 v239, v239, v240
    v_sub_f32 v240, v236, v239
    v_exp_f32 v240, v240
    v_mov_b32 v236, v239
    v_sub_f32 v238, v238, v239
    v_mul_f32 v237, v237, v240
    v_mov_b32_dpp v239, v240 row_ror:8 row_mask:0xf bank_mask:0xf
    v_cndmask_b32 v239, v239, v240, s[12:13]
    v_mul_f32 v208, v208, v239
    v_mul_f32 v209, v209, v239
    v_mul_f32 v210, v210, v239
    v_mul_f32 v211, v211, v239
    v_mul_f32 v212, v212, v239
    v_mul_f32 v213, v213, v239
    v_mul_f32 v214, v214, v239
    v_mul_f32 v215, v215, v239
    s_nop 1
    s_branch BACK_4
SLOW_5:
    s_nop 7
    v_mul_f32 v238, s14, v241
    v_max_f32 v239, v238, v236
    v_mov_b32 v240, v239
    s_nop 1
    v_permlane16_swap_b32 v239, v240
    v_max_f32 v239, v239, v240
    v_mov_b32 v240, v239
    s_nop 1
    v_permlane32_swap_b32 v239, v240
    v_max_f32 v239, v239, v240
    v_sub_f32 v240, v236, v239
    v_exp_f32 v240, v240
    v_mov_b32 v236, v239
    v_sub_f32 v238, v238, v239
    v_mul_f32 v237, v237, v240
    v_mov_b32_dpp v239, v240 row_ror:8 row_mask:0xf bank_mask:0xf
    v_cndmask_b32 v239, v239, v240, s[12:13]
    v_mul_f32 v208, v208, v239
    v_mul_f32 v209, v209, v239
    v_mul_f32 v210, v210, v239
    v_mul_f32 v211, v211, v239
    v_mul_f32 v212, v212, v239
    v_mul_f32 v213, v213, v239
    v_mul_f32 v214, v214, v239
    v_mul_f32 v215, v215, v239
    s_nop 1
    s_branch BACK_6
SLOW_7:
    s_nop 7
    v_mul_f32 v238, s14, v241
    v_max_f32 v239, v238, v236
    v_mov_b32 v240, v239
    s_nop 1
    v_permlane16_swap_b32 v239, v240
    v_max_f32 v239, v239, v240
    v_mov_b32 v240, v239
    s_nop 1
    v_permlane32_swap_b32 v239, v240
    v_max_f32 v239, v239, v240
    v_sub_f32 v240, v236, v239
    v_exp_f32 v240, v240
    v_mov_b32 v236, v239
    v_sub_f32 v238, v238, v239
    v_mul_f32 v237, v237, v240
    v_mov_b32_dpp v239, v240 row_ror:8 row_mask:0xf bank_mask:0xf
    v_cndmask_b32 v239, v239, v240, s[12:13]
    v_mul_f32 v208, v208, v239
    v_mul_f32 v209, v209, v239
    v_mul_f32 v210, v210, v239
    v_mul_f32 v211, v211, v239
    v_mul_f32 v212, v212, v239
    v_mul_f32 v213, v213, v239
    v_mul_f32 v214, v214, v239
    v_mul_f32 v215, v215, v239
    s_nop 1
    s_branch BACK_8
SLOW_9:
    s_nop 7
    v_mul_f32 v238, s14, v241
    v_max_f32 v239, v238, v236
    v_mov_b32 v240, v239
    s_nop 1
    v_permlane16_swap_b32 v239, v240
    v_max_f32 v239, v239, v240
    v_mov_b32 v240, v239
    s_nop 1
    v_permlane32_swap_b32 v239, v240
    v_max_f32 v239, v239, v240
    v_sub_f32 v240, v236, v239
    v_exp_f32 v240, v240
    v_mov_b32 v236, v239
    v_sub_f32 v238, v238, v239
    v_mul_f32 v237, v237, v240
    v_mov_b32_dpp v239, v240 row_ror:8 row_mask:0xf bank_mask:0xf
    v_cndmask_b32 v239, v239, v240, s[12:13]
    v_mul_f32 v208, v208, v239
    v_mul_f32 v209, v209, v239
    v_mul_f32 v210, v210, v239
    v_mul_f32 v211, v211, v239
    v_mul_f32 v212, v212, v239
    v_mul_f32 v213, v213, v239
    v_mul_f32 v214, v214, v239
    v_mul_f32 v215, v215, v239
    s_nop 1
    s_branch BACK_10
SLOW_11:
    s_nop 7
    v_mul_f32 v238, s14, v241
    v_max_f32 v239, v238, v236
    v_mov_b32 v240, v239
    s_nop 1
    v_permlane16_swap_b32 v239, v240
    v_max_f32 v239, v239, v240
    v_mov_b32 v240, v239
    s_nop 1
    v_permlane32_swap_b32 v239, v240
    v_max_f32 v239, v239, v240
    v_sub_f32 v240, v236, v239
    v_exp_f32 v240, v240
    v_mov_b32 v236, v239
    v_sub_f32 v238, v238, v239
    v_mul_f32 v237, v237, v240
    v_mov_b32_dpp v239, v240 row_ror:8 row_mask:0xf bank_mask:0xf
    v_cndmask_b32 v239, v239, v240, s[12:13]
    v_mul_f32 v208, v208, v239
    v_mul_f32 v209, v209, v239
    v_mul_f32 v210, v210, v239
    v_mul_f32 v211, v211, v239
    v_mul_f32 v212, v212, v239
    v_mul_f32 v213, v213, v239
    v_mul_f32 v214, v214, v239
    v_mul_f32 v215, v215, v239
    s_nop 1
    s_branch BACK_12
SLOW_13:
    s_nop 7
    v_mul_f32 v238, s14, v241
    v_max_f32 v239, v238, v236
    v_mov_b32 v240, v239
    s_nop 1
    v_permlane16_swap_b32 v239, v240
    v_max_f32 v239, v239, v240
    v_mov_b32 v240, v239
    s_nop 1
    v_permlane32_swap_b32 v239, v240
    v_max_f32 v239, v239, v240
    v_sub_f32 v240, v236, v239
    v_exp_f32 v240, v240
    v_mov_b32 v236, v239
    v_sub_f32 v238, v238, v239
    v_mul_f32 v237, v237, v240
    v_mov_b32_dpp v239, v240 row_ror:8 row_mask:0xf bank_mask:0xf
    v_cndmask_b32 v239, v239, v240, s[12:13]
    v_mul_f32 v208, v208, v239
    v_mul_f32 v209, v209, v239
    v_mul_f32 v210, v210, v239
    v_mul_f32 v211, v211, v239
    v_mul_f32 v212, v212, v239
    v_mul_f32 v213, v213, v239
    v_mul_f32 v214, v214, v239
    v_mul_f32 v215, v215, v239
    s_nop 1
    s_branch BACK_14
SLOW_15:
    s_nop 7
    v_mul_f32 v238, s14, v241
    v_max_f32 v239, v238, v236
    v_mov_b32 v240, v239
    s_nop 1
    v_permlane16_swap_b32 v239, v240
    v_max_f32 v239, v239, v240
    v_mov_b32 v240, v239
    s_nop 1
    v_permlane32_swap_b32 v239, v240
    v_max_f32 v239, v239, v240
    v_sub_f32 v240, v236, v239
    v_exp_f32 v240, v240
    v_mov_b32 v236, v239
    v_sub_f32 v238, v238, v239
    v_mul_f32 v237, v237, v240
    v_mov_b32_dpp v239, v240 row_ror:8 row_mask:0xf bank_mask:0xf
    v_cndmask_b32 v239, v239, v240, s[12:13]
    v_mul_f32 v208, v208, v239
    v_mul_f32 v209, v209, v239
    v_mul_f32 v210, v210, v239
    v_mul_f32 v211, v211, v239
    v_mul_f32 v212, v212, v239
    v_mul_f32 v213, v213, v239
    v_mul_f32 v214, v214, v239
    v_mul_f32 v215, v215, v239
    s_nop 1
    s_branch BACK_16
SLOW_17:
    s_nop 7
    v_mul_f32 v238, s14, v241
    v_max_f32 v239, v238, v236
    v_mov_b32 v240, v239
    s_nop 1
    v_permlane16_swap_b32 v239, v240
    v_max_f32 v239, v239, v240
    v_mov_b32 v240, v239
    s_nop 1
    v_permlane32_swap_b32 v239, v240
    v_max_f32 v239, v239, v240
    v_sub_f32 v240, v236, v239
    v_exp_f32 v240, v240
    v_mov_b32 v236, v239
    v_sub_f32 v238, v238, v239
    v_mul_f32 v237, v237, v240
    v_mov_b32_dpp v239, v240 row_ror:8 row_mask:0xf bank_mask:0xf
    v_cndmask_b32 v239, v239, v240, s[12:13]
    v_mul_f32 v208, v208, v239
    v_mul_f32 v209, v209, v239
    v_mul_f32 v210, v210, v239
    v_mul_f32 v211, v211, v239
    v_mul_f32 v212, v212, v239
    v_mul_f32 v213, v213, v239
    v_mul_f32 v214, v214, v239
    v_mul_f32 v215, v215, v239
    s_nop 1
    s_branch BACK_18
SLOW_19:
    s_nop 7
    v_mul_f32 v238, s14, v241
    v_max_f32 v239, v238, v236
    v_mov_b32 v240, v239
    s_nop 1
    v_permlane16_swap_b32 v239, v240
    v_max_f32 v239, v239, v240
    v_mov_b32 v240, v239
    s_nop 1
    v_permlane32_swap_b32 v239, v240
    v_max_f32 v239, v239, v240
    v_sub_f32 v240, v236, v239
    v_exp_f32 v240, v240
    v_mov_b32 v236, v239
    v_sub_f32 v238, v238, v239
    v_mul_f32 v237, v237, v240
    v_mov_b32_dpp v239, v240 row_ror:8 row_mask:0xf bank_mask:0xf
    v_cndmask_b32 v239, v239, v240, s[12:13]
    v_mul_f32 v208, v208, v239
    v_mul_f32 v209, v209, v239
    v_mul_f32 v210, v210, v239
    v_mul_f32 v211, v211, v239
    v_mul_f32 v212, v212, v239
    v_mul_f32 v213, v213, v239
    v_mul_f32 v214, v214, v239
    v_mul_f32 v215, v215, v239
    s_nop 1
    s_branch BACK_20
SLOW_21:
    s_nop 7
    v_mul_f32 v238, s14, v241
    v_max_f32 v239, v238, v236
    v_mov_b32 v240, v239
    s_nop 1
    v_permlane16_swap_b32 v239, v240
    v_max_f32 v239, v239, v240
    v_mov_b32 v240, v239
    s_nop 1
    v_permlane32_swap_b32 v239, v240
    v_max_f32 v239, v239, v240
    v_sub_f32 v240, v236, v239
    v_exp_f32 v240, v240
    v_mov_b32 v236, v239
    v_sub_f32 v238, v238, v239
    v_mul_f32 v237, v237, v240
    v_mov_b32_dpp v239, v240 row_ror:8 row_mask:0xf bank_mask:0xf
    v_cndmask_b32 v239, v239, v240, s[12:13]
    v_mul_f32 v208, v208, v239
    v_mul_f32 v209, v209, v239
    v_mul_f32 v210, v210, v239
    v_mul_f32 v211, v211, v239
    v_mul_f32 v212, v212, v239
    v_mul_f32 v213, v213, v239
    v_mul_f32 v214, v214, v239
    v_mul_f32 v215, v215, v239
    s_nop 1
    s_branch BACK_22
SLOW_23:
    s_nop 7
    v_mul_f32 v238, s14, v241
    v_max_f32 v239, v238, v236
    v_mov_b32 v240, v239
    s_nop 1
    v_permlane16_swap_b32 v239, v240
    v_max_f32 v239, v239, v240
    v_mov_b32 v240, v239
    s_nop 1
    v_permlane32_swap_b32 v239, v240
    v_max_f32 v239, v239, v240
    v_sub_f32 v240, v236, v239
    v_exp_f32 v240, v240
    v_mov_b32 v236, v239
    v_sub_f32 v238, v238, v239
    v_mul_f32 v237, v237, v240
    v_mov_b32_dpp v239, v240 row_ror:8 row_mask:0xf bank_mask:0xf
    v_cndmask_b32 v239, v239, v240, s[12:13]
    v_mul_f32 v208, v208, v239
    v_mul_f32 v209, v209, v239
    v_mul_f32 v210, v210, v239
    v_mul_f32 v211, v211, v239
    v_mul_f32 v212, v212, v239
    v_mul_f32 v213, v213, v239
    v_mul_f32 v214, v214, v239
    v_mul_f32 v215, v215, v239
    s_nop 1
    s_branch BACK_24
SLOW_25:
    s_nop 7
    v_mul_f32 v238, s14, v241
    v_max_f32 v239, v238, v236
    v_mov_b32 v240, v239
    s_nop 1
    v_permlane16_swap_b32 v239, v240
    v_max_f32 v239, v239, v240
    v_mov_b32 v240, v239
    s_nop 1
    v_permlane32_swap_b32 v239, v240
    v_max_f32 v239, v239, v240
    v_sub_f32 v240, v236, v239
    v_exp_f32 v240, v240
    v_mov_b32 v236, v239
    v_sub_f32 v238, v238, v239
    v_mul_f32 v237, v237, v240
    v_mov_b32_dpp v239, v240 row_ror:8 row_mask:0xf bank_mask:0xf
    v_cndmask_b32 v239, v239, v240, s[12:13]
    v_mul_f32 v208, v208, v239
    v_mul_f32 v209, v209, v239
    v_mul_f32 v210, v210, v239
    v_mul_f32 v211, v211, v239
    v_mul_f32 v212, v212, v239
    v_mul_f32 v213, v213, v239
    v_mul_f32 v214, v214, v239
    v_mul_f32 v215, v215, v239
    s_nop 1
    s_branch BACK_26
SLOW_27:
    s_nop 7
    v_mul_f32 v238, s14, v241
    v_max_f32 v239, v238, v236
    v_mov_b32 v240, v239
    s_nop 1
    v_permlane16_swap_b32 v239, v240
    v_max_f32 v239, v239, v240
    v_mov_b32 v240, v239
    s_nop 1
    v_permlane32_swap_b32 v239, v240
    v_max_f32 v239, v239, v240
    v_sub_f32 v240, v236, v239
    v_exp_f32 v240, v240
    v_mov_b32 v236, v239
    v_sub_f32 v238, v238, v239
    v_mul_f32 v237, v237, v240
    v_mov_b32_dpp v239, v240 row_ror:8 row_mask:0xf bank_mask:0xf
    v_cndmask_b32 v239, v239, v240, s[12:13]
    v_mul_f32 v208, v208, v239
    v_mul_f32 v209, v209, v239
    v_mul_f32 v210, v210, v239
    v_mul_f32 v211, v211, v239
    v_mul_f32 v212, v212, v239
    v_mul_f32 v213, v213, v239
    v_mul_f32 v214, v214, v239
    v_mul_f32 v215, v215, v239
    s_nop 1
    s_branch BACK_28
SLOW_29:
    s_nop 7
    v_mul_f32 v238, s14, v241
    v_max_f32 v239, v238, v236
    v_mov_b32 v240, v239
    s_nop 1
    v_permlane16_swap_b32 v239, v240
    v_max_f32 v239, v239, v240
    v_mov_b32 v240, v239
    s_nop 1
    v_permlane32_swap_b32 v239, v240
    v_max_f32 v239, v239, v240
    v_sub_f32 v240, v236, v239
    v_exp_f32 v240, v240
    v_mov_b32 v236, v239
    v_sub_f32 v238, v238, v239
    v_mul_f32 v237, v237, v240
    v_mov_b32_dpp v239, v240 row_ror:8 row_mask:0xf bank_mask:0xf
    v_cndmask_b32 v239, v239, v240, s[12:13]
    v_mul_f32 v208, v208, v239
    v_mul_f32 v209, v209, v239
    v_mul_f32 v210, v210, v239
    v_mul_f32 v211, v211, v239
    v_mul_f32 v212, v212, v239
    v_mul_f32 v213, v213, v239
    v_mul_f32 v214, v214, v239
    v_mul_f32 v215, v215, v239
    s_nop 1
    s_branch BACK_30
SLOW_31:
    s_nop 7
    v_mul_f32 v238, s14, v241
    v_max_f32 v239, v238, v236
    v_mov_b32 v240, v239
    s_nop 1
    v_permlane16_swap_b32 v239, v240
    v_max_f32 v239, v239, v240
    v_mov_b32 v240, v239
    s_nop 1
    v_permlane32_swap_b32 v239, v240
    v_max_f32 v239, v239, v240
    v_sub_f32 v240, v236, v239
    v_exp_f32 v240, v240
    v_mov_b32 v236, v239
    v_sub_f32 v238, v238, v239
    v_mul_f32 v237, v237, v240
    v_mov_b32_dpp v239, v240 row_ror:8 row_mask:0xf bank_mask:0xf
    v_cndmask_b32 v239, v239, v240, s[12:13]
    v_mul_f32 v208, v208, v239
    v_mul_f32 v209, v209, v239
    v_mul_f32 v210, v210, v239
    v_mul_f32 v211, v211, v239
    v_mul_f32 v212, v212, v239
    v_mul_f32 v213, v213, v239
    v_mul_f32 v214, v214, v239
    v_mul_f32 v215, v215, v239
    s_nop 1
    s_branch BACK_32
SLOW_33:
    s_nop 7
    v_mul_f32 v238, s14, v241
    v_max_f32 v239, v238, v236
    v_mov_b32 v240, v239
    s_nop 1
    v_permlane16_swap_b32 v239, v240
    v_max_f32 v239, v239, v240
    v_mov_b32 v240, v239
    s_nop 1
    v_permlane32_swap_b32 v239, v240
    v_max_f32 v239, v239, v240
    v_sub_f32 v240, v236, v239
    v_exp_f32 v240, v240
    v_mov_b32 v236, v239
    v_sub_f32 v238, v238, v239
    v_mul_f32 v237, v237, v240
    v_mov_b32_dpp v239, v240 row_ror:8 row_mask:0xf bank_mask:0xf
    v_cndmask_b32 v239, v239, v240, s[12:13]
    v_mul_f32 v208, v208, v239
    v_mul_f32 v209, v209, v239
    v_mul_f32 v210, v210, v239
    v_mul_f32 v211, v211, v239
    v_mul_f32 v212, v212, v239
    v_mul_f32 v213, v213, v239
    v_mul_f32 v214, v214, v239
    v_mul_f32 v215, v215, v239
    s_nop 1
    s_branch BACK_34
SLOW_35:
    s_nop 7
    v_mul_f32 v238, s14, v241
    v_max_f32 v239, v238, v236
    v_mov_b32 v240, v239
    s_nop 1
    v_permlane16_swap_b32 v239, v240
    v_max_f32 v239, v239, v240
    v_mov_b32 v240, v239
    s_nop 1
    v_permlane32_swap_b32 v239, v240
    v_max_f32 v239, v239, v240
    v_sub_f32 v240, v236, v239
    v_exp_f32 v240, v240
    v_mov_b32 v236, v239
    v_sub_f32 v238, v238, v239
    v_mul_f32 v237, v237, v240
    v_mov_b32_dpp v239, v240 row_ror:8 row_mask:0xf bank_mask:0xf
    v_cndmask_b32 v239, v239, v240, s[12:13]
    v_mul_f32 v208, v208, v239
    v_mul_f32 v209, v209, v239
    v_mul_f32 v210, v210, v239
    v_mul_f32 v211, v211, v239
    v_mul_f32 v212, v212, v239
    v_mul_f32 v213, v213, v239
    v_mul_f32 v214, v214, v239
    v_mul_f32 v215, v215, v239
    s_nop 1
    s_branch BACK_36
SLOW_37:
    s_nop 7
    v_mul_f32 v238, s14, v241
    v_max_f32 v239, v238, v236
    v_mov_b32 v240, v239
    s_nop 1
    v_permlane16_swap_b32 v239, v240
    v_max_f32 v239, v239, v240
    v_mov_b32 v240, v239
    s_nop 1
    v_permlane32_swap_b32 v239, v240
    v_max_f32 v239, v239, v240
    v_sub_f32 v240, v236, v239
    v_exp_f32 v240, v240
    v_mov_b32 v236, v239
    v_sub_f32 v238, v238, v239
    v_mul_f32 v237, v237, v240
    v_mov_b32_dpp v239, v240 row_ror:8 row_mask:0xf bank_mask:0xf
    v_cndmask_b32 v239, v239, v240, s[12:13]
    v_mul_f32 v208, v208, v239
    v_mul_f32 v209, v209, v239
    v_mul_f32 v210, v210, v239
    v_mul_f32 v211, v211, v239
    v_mul_f32 v212, v212, v239
    v_mul_f32 v213, v213, v239
    v_mul_f32 v214, v214, v239
    v_mul_f32 v215, v215, v239
    s_nop 1
    s_branch BACK_38
L_helper:
    s_setprio 3
    v_lshlrev_b32 v111, 2, v0
    v_cmp_eq_u32 vcc, 1, v0
    v_mov_b32 v110, 131072
    s_nop 0
    v_cndmask_b32 v110, 0, v110, vcc
    ds_write_b32 v111, v110 offset:9344
    v_mov_b32 v110, 0
    ds_write_b32 v111, v110 offset:9600
    v_lshrrev_b32 v6, 2, v0
    v_and_b32 v7, 3, v0
    v_mul_u32_u24 v1, 56, v6
    v_mul_u32_u24 v2, 229376, v6
    v_lshl_add_u32 v2, v7, 4, v2
    s_lshl_b32 s6, s42, 4
    s_add_u32 s6, s6, s43
    s_lshl_b32 s7, s6, 6
    v_add_u32 v2, s7, v2
    v_mov_b32 v3, 28672
    s_mov_b32 s46, 3670016
    s_mov_b32 s47, 0x00020000
    s_cmp_ge_u32 s43, 16
    s_waitcnt lgkmcnt(0)
    s_mov_b32 s44, s22
    s_mov_b32 s45, s23
    s_cbranch_scc1 L_np
    s_mov_b32 s11, 0
    buffer_load_dwordx4 v[112:115], v2, s[44:47], s11 offen nt
    s_mov_b32 s11, 8192
    buffer_load_dwordx4 v[116:119], v2, s[44:47], s11 offen nt
    s_mov_b32 s11, 16384
    buffer_load_dwordx4 v[120:123], v2, s[44:47], s11 offen nt
    s_mov_b32 s11, 24576
    buffer_load_dwordx4 v[124:127], v2, s[44:47], s11 offen nt
    global_load_dwordx4 v[64:67], v1, s[16:17] offset:0
    global_load_dwordx4 v[68:71], v1, s[16:17] offset:16
    global_load_dwordx4 v[72:75], v1, s[16:17] offset:32
    global_load_dwordx2 v[76:77], v1, s[16:17] offset:48
    global_load_dword v100, v3, s[40:41] sc1
    s_mov_b32 s11, 32768
    buffer_load_dwordx4 v[128:131], v2, s[44:47], s11 offen nt
    s_mov_b32 s11, 40960
    buffer_load_dwordx4 v[132:135], v2, s[44:47], s11 offen nt
    s_mov_b32 s11, 49152
    buffer_load_dwordx4 v[136:139], v2, s[44:47], s11 offen nt
    s_mov_b32 s11, 57344
    buffer_load_dwordx4 v[140:143], v2, s[44:47], s11 offen nt
    s_mov_b32 s11, 65536
    buffer_load_dwordx4 v[144:147], v2, s[44:47], s11 offen nt
    s_mov_b32 s11, 73728
    buffer_load_dwordx4 v[148:151], v2, s[44:47], s11 offen nt
    s_mov_b32 s11, 81920
    buffer_load_dwordx4 v[152:155], v2, s[44:47], s11 offen nt
    s_mov_b32 s11, 90112
    buffer_load_dwordx4 v[156:159], v2, s[44:47], s11 offen nt
    s_mov_b32 s11, 98304
    buffer_load_dwordx4 v[160:163], v2, s[44:47], s11 offen nt
    s_mov_b32 s11, 106496
    buffer_load_dwordx4 v[164:167], v2, s[44:47], s11 offen nt
    s_mov_b32 s11, 114688
    buffer_load_dwordx4 v[168:171], v2, s[44:47], s11 offen nt
    s_mov_b32 s11, 122880
    buffer_load_dwordx4 v[172:175], v2, s[44:47], s11 offen nt
    s_mov_b32 s11, 131072
    buffer_load_dwordx4 v[176:179], v2, s[44:47], s11 offen nt
    s_mov_b32 s11, 139264
    buffer_load_dwordx4 v[180:183], v2, s[44:47], s11 offen nt
    s_mov_b32 s11, 147456
    buffer_load_dwordx4 v[184:187], v2, s[44:47], s11 offen nt
    s_mov_b32 s11, 155648
    buffer_load_dwordx4 v[188:191], v2, s[44:47], s11 offen nt
    s_mov_b32 s11, 163840
    buffer_load_dwordx4 v[192:195], v2, s[44:47], s11 offen nt
    s_mov_b32 s11, 172032
    buffer_load_dwordx4 v[196:199], v2, s[44:47], s11 offen nt
    s_mov_b32 s11, 180224
    buffer_load_dwordx4 v[200:203], v2, s[44:47], s11 offen nt
    s_mov_b32 s11, 188416
    buffer_load_dwordx4 v[204:207], v2, s[44:47], s11 offen nt
    s_mov_b32 s11, 196608
    buffer_load_dwordx4 v[208:211], v2, s[44:47], s11 offen nt
    s_mov_b32 s11, 204800
    buffer_load_dwordx4 v[212:215], v2, s[44:47], s11 offen nt
    s_mov_b32 s11, 212992
    buffer_load_dwordx4 v[216:219], v2, s[44:47], s11 offen nt
    s_mov_b32 s11, 221184
    buffer_load_dwordx4 v[220:223], v2, s[44:47], s11 offen nt
    s_barrier
    v_and_b32 v6, 1, v4
    v_lshlrev_b32 v6, 4, v6
    v_mov_b32 v7, 0xffff
    v_lshlrev_b32 v7, v6, v7
    v_lshrrev_b32 v6, 1, v4
    v_and_b32 v6, 3, v6
    v_cmp_eq_u32 vcc, 0, v6
    s_nop 1
    v_cndmask_b32 v232, 0, v7, vcc
    v_cmp_eq_u32 vcc, 1, v6
    s_nop 1
    v_cndmask_b32 v233, 0, v7, vcc
    v_cmp_eq_u32 vcc, 2, v6
    s_nop 1
    v_cndmask_b32 v234, 0, v7, vcc
    v_cmp_eq_u32 vcc, 3, v6
    s_nop 1
    v_cndmask_b32 v235, 0, v7, vcc
    s_sub_u32 s9, s43, 16
    s_mul_i32 s8, s42, 7
    s_add_u32 s8, s8, s9
    s_lshl_b32 s7, s4, 12
    s_add_u32 s7, s7, 393216
    v_mov_b32 v226, s7
    v_mov_b32 v227, 0
    s_mov_b32 s57, 0xffffff00
    s_lshl_b32 s7, s4, 11
    s_add_u32 s7, s7, 0
    v_lshlrev_b32 v106, 5, v0
    v_add_u32 v106, s7, v106
    v_mov_b32 v105, 9248
    s_mov_b32 s15, 0
    v_mov_b32 v92, 0
    v_mov_b32 v93, 0
    v_mov_b32 v94, 0
    v_mov_b32 v95, 0
    v_mov_b32 v96, 0
    v_mov_b32 v97, 0
    v_mov_b32 v98, 0
    v_mov_b32 v99, 0
    v_and_b32 v7, 3, v0
    v_lshlrev_b32 v7, 5, v7
    v_lshl_add_u32 v7, v5, 3, v7
    s_lshl_b32 s7, s6, 7
    s_add_u32 s7, s7, 0
    v_add_u32 v7, s7, v7
    s_waitcnt vmcnt(24)
    v_and_b32 v8, 0xffff, v64
    v_lshlrev_b32 v36, 16, v64
    v_lshrrev_b32 v9, 16, v64
    v_and_b32 v37, 0xffff0000, v64
    v_and_b32 v10, 0xffff, v65
    v_lshlrev_b32 v38, 16, v65
    v_lshrrev_b32 v11, 16, v65
    v_and_b32 v39, 0xffff0000, v65
    v_and_b32 v12, 0xffff, v66
    v_lshlrev_b32 v40, 16, v66
    v_lshrrev_b32 v13, 16, v66
    v_and_b32 v41, 0xffff0000, v66
    v_and_b32 v14, 0xffff, v67
    v_lshlrev_b32 v42, 16, v67
    v_lshrrev_b32 v15, 16, v67
    v_and_b32 v43, 0xffff0000, v67
    v_and_b32 v16, 0xffff, v68
    v_lshlrev_b32 v44, 16, v68
    v_lshrrev_b32 v17, 16, v68
    v_and_b32 v45, 0xffff0000, v68
    v_and_b32 v18, 0xffff, v69
    v_lshlrev_b32 v46, 16, v69
    v_lshrrev_b32 v19, 16, v69
    v_and_b32 v47, 0xffff0000, v69
    v_and_b32 v20, 0xffff, v70
    v_lshlrev_b32 v48, 16, v70
    v_lshrrev_b32 v21, 16, v70
    v_and_b32 v49, 0xffff0000, v70
    v_and_b32 v22, 0xffff, v71
    v_lshlrev_b32 v50, 16, v71
    v_lshrrev_b32 v23, 16, v71
    v_and_b32 v51, 0xffff0000, v71
    v_and_b32 v24, 0xffff, v72
    v_lshlrev_b32 v52, 16, v72
    v_lshrrev_b32 v25, 16, v72
    v_and_b32 v53, 0xffff0000, v72
    v_and_b32 v26, 0xffff, v73
    v_lshlrev_b32 v54, 16, v73
    v_lshrrev_b32 v27, 16, v73
    v_and_b32 v55, 0xffff0000, v73
    v_and_b32 v28, 0xffff, v74
    v_lshlrev_b32 v56, 16, v74
    v_lshrrev_b32 v29, 16, v74
    v_and_b32 v57, 0xffff0000, v74
    v_and_b32 v30, 0xffff, v75
    v_lshlrev_b32 v58, 16, v75
    v_lshrrev_b32 v31, 16, v75
    v_and_b32 v59, 0xffff0000, v75
    v_and_b32 v32, 0xffff, v76
    v_lshlrev_b32 v60, 16, v76
    v_lshrrev_b32 v33, 16, v76
    v_and_b32 v61, 0xffff0000, v76
    v_and_b32 v34, 0xffff, v77
    v_lshlrev_b32 v62, 16, v77
    v_lshrrev_b32 v35, 16, v77
    v_and_b32 v63, 0xffff0000, v77
    v_and_b32 v224, 0xff, v100
    v_cmp_eq_u32 vcc, 0xff, v224
    s_nop 1
    v_cndmask_b32 v224, v224, 0, vcc
    v_add_u32 v224, 1, v224
    s_mov_b32 s7, 0x01010101
    v_mul_lo_u32 v100, v224, s7
    ds_write_b32 v105, v224
    v_dot2_f32_bf16 v92, v112, v8, v92
    v_dot2_f32_bf16 v93, v112, v36, v93
    v_dot2_f32_bf16 v94, v113, v8, v94
    v_dot2_f32_bf16 v95, v113, v36, v95
    v_dot2_f32_bf16 v96, v114, v8, v96
    v_dot2_f32_bf16 v97, v114, v36, v97
    v_dot2_f32_bf16 v98, v115, v8, v98
    v_dot2_f32_bf16 v99, v115, v36, v99
    v_dot2_f32_bf16 v92, v116, v9, v92
    v_dot2_f32_bf16 v93, v116, v37, v93
    v_dot2_f32_bf16 v94, v117, v9, v94
    v_dot2_f32_bf16 v95, v117, v37, v95
    v_dot2_f32_bf16 v96, v118, v9, v96
    v_dot2_f32_bf16 v97, v118, v37, v97
    v_dot2_f32_bf16 v98, v119, v9, v98
    v_dot2_f32_bf16 v99, v119, v37, v99
    v_dot2_f32_bf16 v92, v120, v10, v92
    v_dot2_f32_bf16 v93, v120, v38, v93
    v_dot2_f32_bf16 v94, v121, v10, v94
    v_dot2_f32_bf16 v95, v121, v38, v95
    v_dot2_f32_bf16 v96, v122, v10, v96
    v_dot2_f32_bf16 v97, v122, v38, v97
    v_dot2_f32_bf16 v98, v123, v10, v98
    v_dot2_f32_bf16 v99, v123, v38, v99
    v_dot2_f32_bf16 v92, v124, v11, v92
    v_dot2_f32_bf16 v93, v124, v39, v93
    v_dot2_f32_bf16 v94, v125, v11, v94
    v_dot2_f32_bf16 v95, v125, v39, v95
    v_dot2_f32_bf16 v96, v126, v11, v96
    v_dot2_f32_bf16 v97, v126, v39, v97
    v_dot2_f32_bf16 v98, v127, v11, v98
    v_dot2_f32_bf16 v99, v127, v39, v99
    s_waitcnt vmcnt(23)
    v_dot2_f32_bf16 v92, v128, v12, v92
    v_dot2_f32_bf16 v93, v128, v40, v93
    v_dot2_f32_bf16 v94, v129, v12, v94
    v_dot2_f32_bf16 v95, v129, v40, v95
    v_dot2_f32_bf16 v96, v130, v12, v96
    v_dot2_f32_bf16 v97, v130, v40, v97
    v_dot2_f32_bf16 v98, v131, v12, v98
    v_dot2_f32_bf16 v99, v131, v40, v99
    s_waitcnt vmcnt(22)
    v_dot2_f32_bf16 v92, v132, v13, v92
    v_dot2_f32_bf16 v93, v132, v41, v93
    v_dot2_f32_bf16 v94, v133, v13, v94
    v_dot2_f32_bf16 v95, v133, v41, v95
    v_dot2_f32_bf16 v96, v134, v13, v96
    v_dot2_f32_bf16 v97, v134, v41, v97
    v_dot2_f32_bf16 v98, v135, v13, v98
    v_dot2_f32_bf16 v99, v135, v41, v99
    s_waitcnt vmcnt(21)
    v_dot2_f32_bf16 v92, v136, v14, v92
    v_dot2_f32_bf16 v93, v136, v42, v93
    v_dot2_f32_bf16 v94, v137, v14, v94
    v_dot2_f32_bf16 v95, v137, v42, v95
    v_dot2_f32_bf16 v96, v138, v14, v96
    v_dot2_f32_bf16 v97, v138, v42, v97
    v_dot2_f32_bf16 v98, v139, v14, v98
    v_dot2_f32_bf16 v99, v139, v42, v99
    s_waitcnt vmcnt(20)
    v_dot2_f32_bf16 v92, v140, v15, v92
    v_dot2_f32_bf16 v93, v140, v43, v93
    v_dot2_f32_bf16 v94, v141, v15, v94
    v_dot2_f32_bf16 v95, v141, v43, v95
    v_dot2_f32_bf16 v96, v142, v15, v96
    v_dot2_f32_bf16 v97, v142, v43, v97
    v_dot2_f32_bf16 v98, v143, v15, v98
    v_dot2_f32_bf16 v99, v143, v43, v99
    s_waitcnt vmcnt(19)
    v_dot2_f32_bf16 v92, v144, v16, v92
    v_dot2_f32_bf16 v93, v144, v44, v93
    v_dot2_f32_bf16 v94, v145, v16, v94
    v_dot2_f32_bf16 v95, v145, v44, v95
    v_dot2_f32_bf16 v96, v146, v16, v96
    v_dot2_f32_bf16 v97, v146, v44, v97
    v_dot2_f32_bf16 v98, v147, v16, v98
    v_dot2_f32_bf16 v99, v147, v44, v99
    s_waitcnt vmcnt(18)
    v_dot2_f32_bf16 v92, v148, v17, v92
    v_dot2_f32_bf16 v93, v148, v45, v93
    v_dot2_f32_bf16 v94, v149, v17, v94
    v_dot2_f32_bf16 v95, v149, v45, v95
    v_dot2_f32_bf16 v96, v150, v17, v96
    v_dot2_f32_bf16 v97, v150, v45, v97
    v_dot2_f32_bf16 v98, v151, v17, v98
    v_dot2_f32_bf16 v99, v151, v45, v99
    s_waitcnt vmcnt(17)
    v_dot2_f32_bf16 v92, v152, v18, v92
    v_dot2_f32_bf16 v93, v152, v46, v93
    v_dot2_f32_bf16 v94, v153, v18, v94
    v_dot2_f32_bf16 v95, v153, v46, v95
    v_dot2_f32_bf16 v96, v154, v18, v96
    v_dot2_f32_bf16 v97, v154, v46, v97
    v_dot2_f32_bf16 v98, v155, v18, v98
    v_dot2_f32_bf16 v99, v155, v46, v99
    s_waitcnt vmcnt(16)
    v_dot2_f32_bf16 v92, v156, v19, v92
    v_dot2_f32_bf16 v93, v156, v47, v93
    v_dot2_f32_bf16 v94, v157, v19, v94
    v_dot2_f32_bf16 v95, v157, v47, v95
    v_dot2_f32_bf16 v96, v158, v19, v96
    v_dot2_f32_bf16 v97, v158, v47, v97
    v_dot2_f32_bf16 v98, v159, v19, v98
    v_dot2_f32_bf16 v99, v159, v47, v99
    s_waitcnt vmcnt(15)
    v_dot2_f32_bf16 v92, v160, v20, v92
    v_dot2_f32_bf16 v93, v160, v48, v93
    v_dot2_f32_bf16 v94, v161, v20, v94
    v_dot2_f32_bf16 v95, v161, v48, v95
    v_dot2_f32_bf16 v96, v162, v20, v96
    v_dot2_f32_bf16 v97, v162, v48, v97
    v_dot2_f32_bf16 v98, v163, v20, v98
    v_dot2_f32_bf16 v99, v163, v48, v99
    s_waitcnt vmcnt(14)
    v_dot2_f32_bf16 v92, v164, v21, v92
    v_dot2_f32_bf16 v93, v164, v49, v93
    v_dot2_f32_bf16 v94, v165, v21, v94
    v_dot2_f32_bf16 v95, v165, v49, v95
    v_dot2_f32_bf16 v96, v166, v21, v96
    v_dot2_f32_bf16 v97, v166, v49, v97
    v_dot2_f32_bf16 v98, v167, v21, v98
    v_dot2_f32_bf16 v99, v167, v49, v99
    s_waitcnt vmcnt(13)
    v_dot2_f32_bf16 v92, v168, v22, v92
    v_dot2_f32_bf16 v93, v168, v50, v93
    v_dot2_f32_bf16 v94, v169, v22, v94
    v_dot2_f32_bf16 v95, v169, v50, v95
    v_dot2_f32_bf16 v96, v170, v22, v96
    v_dot2_f32_bf16 v97, v170, v50, v97
    v_dot2_f32_bf16 v98, v171, v22, v98
    v_dot2_f32_bf16 v99, v171, v50, v99
    s_waitcnt vmcnt(12)
    v_dot2_f32_bf16 v92, v172, v23, v92
    v_dot2_f32_bf16 v93, v172, v51, v93
    v_dot2_f32_bf16 v94, v173, v23, v94
    v_dot2_f32_bf16 v95, v173, v51, v95
    v_dot2_f32_bf16 v96, v174, v23, v96
    v_dot2_f32_bf16 v97, v174, v51, v97
    v_dot2_f32_bf16 v98, v175, v23, v98
    v_dot2_f32_bf16 v99, v175, v51, v99
    s_waitcnt vmcnt(11)
    v_dot2_f32_bf16 v92, v176, v24, v92
    v_dot2_f32_bf16 v93, v176, v52, v93
    v_dot2_f32_bf16 v94, v177, v24, v94
    v_dot2_f32_bf16 v95, v177, v52, v95
    v_dot2_f32_bf16 v96, v178, v24, v96
    v_dot2_f32_bf16 v97, v178, v52, v97
    v_dot2_f32_bf16 v98, v179, v24, v98
    v_dot2_f32_bf16 v99, v179, v52, v99
    s_waitcnt vmcnt(10)
    v_dot2_f32_bf16 v92, v180, v25, v92
    v_dot2_f32_bf16 v93, v180, v53, v93
    v_dot2_f32_bf16 v94, v181, v25, v94
    v_dot2_f32_bf16 v95, v181, v53, v95
    v_dot2_f32_bf16 v96, v182, v25, v96
    v_dot2_f32_bf16 v97, v182, v53, v97
    v_dot2_f32_bf16 v98, v183, v25, v98
    v_dot2_f32_bf16 v99, v183, v53, v99
    s_waitcnt vmcnt(9)
    v_dot2_f32_bf16 v92, v184, v26, v92
    v_dot2_f32_bf16 v93, v184, v54, v93
    v_dot2_f32_bf16 v94, v185, v26, v94
    v_dot2_f32_bf16 v95, v185, v54, v95
    v_dot2_f32_bf16 v96, v186, v26, v96
    v_dot2_f32_bf16 v97, v186, v54, v97
    v_dot2_f32_bf16 v98, v187, v26, v98
    v_dot2_f32_bf16 v99, v187, v54, v99
    s_waitcnt vmcnt(8)
    v_dot2_f32_bf16 v92, v188, v27, v92
    v_dot2_f32_bf16 v93, v188, v55, v93
    v_dot2_f32_bf16 v94, v189, v27, v94
    v_dot2_f32_bf16 v95, v189, v55, v95
    v_dot2_f32_bf16 v96, v190, v27, v96
    v_dot2_f32_bf16 v97, v190, v55, v97
    v_dot2_f32_bf16 v98, v191, v27, v98
    v_dot2_f32_bf16 v99, v191, v55, v99
    s_waitcnt vmcnt(7)
    v_dot2_f32_bf16 v92, v192, v28, v92
    v_dot2_f32_bf16 v93, v192, v56, v93
    v_dot2_f32_bf16 v94, v193, v28, v94
    v_dot2_f32_bf16 v95, v193, v56, v95
    v_dot2_f32_bf16 v96, v194, v28, v96
    v_dot2_f32_bf16 v97, v194, v56, v97
    v_dot2_f32_bf16 v98, v195, v28, v98
    v_dot2_f32_bf16 v99, v195, v56, v99
    s_waitcnt vmcnt(6)
    v_dot2_f32_bf16 v92, v196, v29, v92
    v_dot2_f32_bf16 v93, v196, v57, v93
    v_dot2_f32_bf16 v94, v197, v29, v94
    v_dot2_f32_bf16 v95, v197, v57, v95
    v_dot2_f32_bf16 v96, v198, v29, v96
    v_dot2_f32_bf16 v97, v198, v57, v97
    v_dot2_f32_bf16 v98, v199, v29, v98
    v_dot2_f32_bf16 v99, v199, v57, v99
    s_waitcnt vmcnt(5)
    v_dot2_f32_bf16 v92, v200, v30, v92
    v_dot2_f32_bf16 v93, v200, v58, v93
    v_dot2_f32_bf16 v94, v201, v30, v94
    v_dot2_f32_bf16 v95, v201, v58, v95
    v_dot2_f32_bf16 v96, v202, v30, v96
    v_dot2_f32_bf16 v97, v202, v58, v97
    v_dot2_f32_bf16 v98, v203, v30, v98
    v_dot2_f32_bf16 v99, v203, v58, v99
    s_waitcnt vmcnt(4)
    v_dot2_f32_bf16 v92, v204, v31, v92
    v_dot2_f32_bf16 v93, v204, v59, v93
    v_dot2_f32_bf16 v94, v205, v31, v94
    v_dot2_f32_bf16 v95, v205, v59, v95
    v_dot2_f32_bf16 v96, v206, v31, v96
    v_dot2_f32_bf16 v97, v206, v59, v97
    v_dot2_f32_bf16 v98, v207, v31, v98
    v_dot2_f32_bf16 v99, v207, v59, v99
    s_waitcnt vmcnt(3)
    v_dot2_f32_bf16 v92, v208, v32, v92
    v_dot2_f32_bf16 v93, v208, v60, v93
    v_dot2_f32_bf16 v94, v209, v32, v94
    v_dot2_f32_bf16 v95, v209, v60, v95
    v_dot2_f32_bf16 v96, v210, v32, v96
    v_dot2_f32_bf16 v97, v210, v60, v97
    v_dot2_f32_bf16 v98, v211, v32, v98
    v_dot2_f32_bf16 v99, v211, v60, v99
    s_waitcnt vmcnt(2)
    v_dot2_f32_bf16 v92, v212, v33, v92
    v_dot2_f32_bf16 v93, v212, v61, v93
    v_dot2_f32_bf16 v94, v213, v33, v94
    v_dot2_f32_bf16 v95, v213, v61, v95
    v_dot2_f32_bf16 v96, v214, v33, v96
    v_dot2_f32_bf16 v97, v214, v61, v97
    v_dot2_f32_bf16 v98, v215, v33, v98
    v_dot2_f32_bf16 v99, v215, v61, v99
    s_waitcnt vmcnt(1)
    v_dot2_f32_bf16 v92, v216, v34, v92
    v_dot2_f32_bf16 v93, v216, v62, v93
    v_dot2_f32_bf16 v94, v217, v34, v94
    v_dot2_f32_bf16 v95, v217, v62, v95
    v_dot2_f32_bf16 v96, v218, v34, v96
    v_dot2_f32_bf16 v97, v218, v62, v97
    v_dot2_f32_bf16 v98, v219, v34, v98
    v_dot2_f32_bf16 v99, v219, v62, v99
    s_waitcnt vmcnt(0)
    v_dot2_f32_bf16 v92, v220, v35, v92
    v_dot2_f32_bf16 v93, v220, v63, v93
    v_dot2_f32_bf16 v94, v221, v35, v94
    v_dot2_f32_bf16 v95, v221, v63, v95
    v_dot2_f32_bf16 v96, v222, v35, v96
    v_dot2_f32_bf16 v97, v222, v63, v97
    v_dot2_f32_bf16 v98, v223, v35, v98
    v_dot2_f32_bf16 v99, v223, v63, v99
    v_permlane32_swap_b32 v92, v96
    v_permlane32_swap_b32 v93, v97
    v_permlane32_swap_b32 v94, v98
    v_permlane32_swap_b32 v95, v99
    v_add_f32 v92, v92, v96
    v_add_f32 v93, v93, v97
    v_add_f32 v94, v94, v98
    v_add_f32 v95, v95, v99
    s_nop 0
    v_permlane16_swap_b32 v92, v94
    v_permlane16_swap_b32 v93, v95
    v_add_f32 v92, v92, v94
    v_add_f32 v93, v93, v95
    s_nop 0
    v_add_f32_dpp v92, v92, v92 row_ror:4 row_mask:0xf bank_mask:0xf
    v_add_f32_dpp v93, v93, v93 row_ror:4 row_mask:0xf bank_mask:0xf
    s_nop 0
    v_add_f32_dpp v92, v92, v92 row_ror:8 row_mask:0xf bank_mask:0xf
    v_add_f32_dpp v93, v93, v93 row_ror:8 row_mask:0xf bank_mask:0xf
    v_cvt_pk_bf16_f32 v94, v92, v93
    v_mov_b32 v95, v100
    s_mov_b32 exec_lo, 0x000f000f
    s_mov_b32 exec_hi, 0x000f000f
    global_store_dwordx2 v7, v[94:95], s[40:41] sc1
    s_mov_b64 exec, 1
    s_cmp_lg_u32 s5, 0
    s_cbranch_scc1 L_noct
    global_store_dword v226, v227, s[40:41] sc1
L_noct:
    s_mov_b64 exec, -1
    s_sleep 56
L_pollQa:
    global_load_dwordx4 v[112:115], v106, s[40:41] sc1
    global_load_dwordx4 v[116:119], v106, s[40:41] offset:16 sc1
L_pollQwa:
    s_waitcnt vmcnt(0)
    v_xor_b32 v101, v113, v100
    v_xor_b32 v102, v115, v100
    v_xor_b32 v103, v117, v100
    v_xor_b32 v104, v119, v100
    v_or3_b32 v101, v101, v102, v103
    v_or_b32 v101, v101, v104
    v_cmp_ne_u32 vcc, 0, v101
    s_add_u32 s15, s15, 1
    s_cmp_ge_u32 s15, 65536
    s_cbranch_scc1 L_pollQ_donea
    s_and_b64 exec, exec, vcc
    s_cbranch_scc0 L_pollQ_donea
    s_sleep 8
    s_branch L_pollQa
L_pollQ_donea:
    s_mov_b64 exec, -1
    v_mov_b32 v113, v114
    v_mov_b32 v114, v116
    v_mov_b32 v115, v118
    v_lshlrev_b32 v101, 4, v0
    ds_write_b128 v101, v[112:115]
    v_mov_b32 v102, 9344
    v_mov_b32 v103, 1
    ds_write_b32 v102, v103
    global_load_dwordx4 v[80:83], v1, s[34:35] offset:0
    global_load_dwordx4 v[84:87], v1, s[34:35] offset:16
    global_load_dwordx4 v[88:91], v1, s[34:35] offset:32
    global_load_dwordx2 v[92:93], v1, s[34:35] offset:48
    s_waitcnt vmcnt(0)
    v_mov_b32 v107, 0x3f803f80
    v_mov_b32 v229, 0
    v_lshlrev_b32 v108, 16, v80
    v_and_b32 v109, 0xffff0000, v80
    v_mul_f32 v108, v108, v36
    v_mul_f32 v109, v109, v37
    v_cvt_pk_bf16_f32 v80, v108, v109
    v_lshlrev_b32 v108, 16, v81
    v_and_b32 v109, 0xffff0000, v81
    v_mul_f32 v108, v108, v38
    v_mul_f32 v109, v109, v39
    v_cvt_pk_bf16_f32 v81, v108, v109
    v_lshlrev_b32 v108, 16, v82
    v_and_b32 v109, 0xffff0000, v82
    v_mul_f32 v108, v108, v40
    v_mul_f32 v109, v109, v41
    v_cvt_pk_bf16_f32 v82, v108, v109
    v_lshlrev_b32 v108, 16, v83
    v_and_b32 v109, 0xffff0000, v83
    v_mul_f32 v108, v108, v42
    v_mul_f32 v109, v109, v43
    v_cvt_pk_bf16_f32 v83, v108, v109
    v_lshlrev_b32 v108, 16, v84
    v_and_b32 v109, 0xffff0000, v84
    v_mul_f32 v108, v108, v44
    v_mul_f32 v109, v109, v45
    v_cvt_pk_bf16_f32 v84, v108, v109
    v_lshlrev_b32 v108, 16, v85
    v_and_b32 v109, 0xffff0000, v85
    v_mul_f32 v108, v108, v46
    v_mul_f32 v109, v109, v47
    v_cvt_pk_bf16_f32 v85, v108, v109
    v_lshlrev_b32 v108, 16, v86
    v_and_b32 v109, 0xffff0000, v86
    v_mul_f32 v108, v108, v48
    v_mul_f32 v109, v109, v49
    v_cvt_pk_bf16_f32 v86, v108, v109
    v_lshlrev_b32 v108, 16, v87
    v_and_b32 v109, 0xffff0000, v87
    v_mul_f32 v108, v108, v50
    v_mul_f32 v109, v109, v51
    v_cvt_pk_bf16_f32 v87, v108, v109
    v_lshlrev_b32 v108, 16, v88
    v_and_b32 v109, 0xffff0000, v88
    v_mul_f32 v108, v108, v52
    v_mul_f32 v109, v109, v53
    v_cvt_pk_bf16_f32 v88, v108, v109
    v_lshlrev_b32 v108, 16, v89
    v_and_b32 v109, 0xffff0000, v89
    v_mul_f32 v108, v108, v54
    v_mul_f32 v109, v109, v55
    v_cvt_pk_bf16_f32 v89, v108, v109
    v_lshlrev_b32 v108, 16, v90
    v_and_b32 v109, 0xffff0000, v90
    v_mul_f32 v108, v108, v56
    v_mul_f32 v109, v109, v57
    v_cvt_pk_bf16_f32 v90, v108, v109
    v_lshlrev_b32 v108, 16, v91
    v_and_b32 v109, 0xffff0000, v91
    v_mul_f32 v108, v108, v58
    v_mul_f32 v109, v109, v59
    v_cvt_pk_bf16_f32 v91, v108, v109
    v_lshlrev_b32 v108, 16, v92
    v_and_b32 v109, 0xffff0000, v92
    v_mul_f32 v108, v108, v60
    v_mul_f32 v109, v109, v61
    v_cvt_pk_bf16_f32 v92, v108, v109
    v_lshlrev_b32 v108, 16, v93
    v_and_b32 v109, 0xffff0000, v93
    v_mul_f32 v108, v108, v62
    v_mul_f32 v109, v109, v63
    v_cvt_pk_bf16_f32 v93, v108, v109
    v_dot2_f32_bf16 v229, v80, v107, v229
    v_dot2_f32_bf16 v229, v81, v107, v229
    v_dot2_f32_bf16 v229, v82, v107, v229
    v_dot2_f32_bf16 v229, v83, v107, v229
    v_dot2_f32_bf16 v229, v84, v107, v229
    v_dot2_f32_bf16 v229, v85, v107, v229
    v_dot2_f32_bf16 v229, v86, v107, v229
    v_dot2_f32_bf16 v229, v87, v107, v229
    v_dot2_f32_bf16 v229, v88, v107, v229
    v_dot2_f32_bf16 v229, v89, v107, v229
    v_dot2_f32_bf16 v229, v90, v107, v229
    v_dot2_f32_bf16 v229, v91, v107, v229
    v_dot2_f32_bf16 v229, v92, v107, v229
    v_dot2_f32_bf16 v229, v93, v107, v229
    s_nop 2
    v_add_f32_dpp v229, v229, v229 row_ror:4 row_mask:0xf bank_mask:0xf
    s_nop 1
    v_add_f32_dpp v229, v229, v229 row_ror:8 row_mask:0xf bank_mask:0xf
    v_mov_b32 v108, v229
    s_nop 1
    v_permlane16_swap_b32 v229, v108
    v_add_f32 v229, v229, v108
    v_mov_b32 v108, v229
    s_nop 1
    v_permlane32_swap_b32 v229, v108
    v_add_f32 v229, v229, v108
    v_cvt_pk_bf16_f32 v229, v229, v229
    v_and_b32 v229, 0xffff0000, v229
    v_mul_f32 v229, 0xbfb8aa3b, v229
    v_exp_f32 v229, v229
    s_nop 0
    v_add_f32 v229, 1.0, v229
    v_rcp_f32 v229, v229
    s_nop 0
    v_cvt_pk_bf16_f32 v229, v229, v229
    v_and_b32 v229, 0xffff0000, v229
    v_sub_f32 v230, 1.0, v229
    v_cvt_pk_bf16_f32 v230, v230, v230
    v_and_b32 v230, 0xffff0000, v230
    ds_write_b32 v105, v229 offset:4
    s_branch L_noffn
L_np:
    global_load_dwordx4 v[64:67], v1, s[16:17] offset:0
    global_load_dwordx4 v[68:71], v1, s[16:17] offset:16
    global_load_dwordx4 v[72:75], v1, s[16:17] offset:32
    global_load_dwordx2 v[76:77], v1, s[16:17] offset:48
    global_load_dword v100, v3, s[40:41] sc1
    global_load_dwordx4 v[80:83], v1, s[34:35] offset:0
    global_load_dwordx4 v[84:87], v1, s[34:35] offset:16
    global_load_dwordx4 v[88:91], v1, s[34:35] offset:32
    global_load_dwordx2 v[92:93], v1, s[34:35] offset:48
    s_barrier
    v_and_b32 v6, 1, v4
    v_lshlrev_b32 v6, 4, v6
    v_mov_b32 v7, 0xffff
    v_lshlrev_b32 v7, v6, v7
    v_lshrrev_b32 v6, 1, v4
    v_and_b32 v6, 3, v6
    v_cmp_eq_u32 vcc, 0, v6
    s_nop 1
    v_cndmask_b32 v232, 0, v7, vcc
    v_cmp_eq_u32 vcc, 1, v6
    s_nop 1
    v_cndmask_b32 v233, 0, v7, vcc
    v_cmp_eq_u32 vcc, 2, v6
    s_nop 1
    v_cndmask_b32 v234, 0, v7, vcc
    v_cmp_eq_u32 vcc, 3, v6
    s_nop 1
    v_cndmask_b32 v235, 0, v7, vcc
    s_sub_u32 s9, s43, 16
    s_mul_i32 s8, s42, 7
    s_add_u32 s8, s8, s9
    s_lshl_b32 s7, s4, 12
    s_add_u32 s7, s7, 393216
    v_mov_b32 v226, s7
    v_mov_b32 v227, 0
    s_mov_b32 s57, 0xffffff00
    s_lshl_b32 s7, s4, 11
    s_add_u32 s7, s7, 0
    v_lshlrev_b32 v106, 5, v0
    v_add_u32 v106, s7, v106
    v_mov_b32 v105, 9248
    s_mov_b32 s15, 0
    v_lshrrev_b32 v6, 2, v0
    v_and_b32 v7, 3, v0
    v_mul_u32_u24 v6, 100352, v6
    v_lshl_add_u32 v6, v7, 4, v6
    s_lshl_b32 s7, s8, 6
    v_add_u32 v6, s7, v6
    v_lshlrev_b32 v2, 5, v4
    v_lshl_add_u32 v2, v5, 4, v2
    s_lshl_b32 s7, s8, 11
    s_add_u32 s7, s7, 655360
    v_add_u32 v2, s7, v2
    s_mov_b32 s44, s28
    s_mov_b32 s45, s29
    s_mov_b32 s46, 1605632
    s_mov_b32 s48, s30
    s_mov_b32 s49, s31
    s_mov_b32 s50, 1605632
    s_mov_b32 s51, 0x00020000
    s_waitcnt vmcnt(0)
    v_and_b32 v8, 0xffff, v64
    v_lshlrev_b32 v36, 16, v64
    v_lshrrev_b32 v9, 16, v64
    v_and_b32 v37, 0xffff0000, v64
    v_and_b32 v10, 0xffff, v65
    v_lshlrev_b32 v38, 16, v65
    v_lshrrev_b32 v11, 16, v65
    v_and_b32 v39, 0xffff0000, v65
    v_and_b32 v12, 0xffff, v66
    v_lshlrev_b32 v40, 16, v66
    v_lshrrev_b32 v13, 16, v66
    v_and_b32 v41, 0xffff0000, v66
    v_and_b32 v14, 0xffff, v67
    v_lshlrev_b32 v42, 16, v67
    v_lshrrev_b32 v15, 16, v67
    v_and_b32 v43, 0xffff0000, v67
    v_and_b32 v16, 0xffff, v68
    v_lshlrev_b32 v44, 16, v68
    v_lshrrev_b32 v17, 16, v68
    v_and_b32 v45, 0xffff0000, v68
    v_and_b32 v18, 0xffff, v69
    v_lshlrev_b32 v46, 16, v69
    v_lshrrev_b32 v19, 16, v69
    v_and_b32 v47, 0xffff0000, v69
    v_and_b32 v20, 0xffff, v70
    v_lshlrev_b32 v48, 16, v70
    v_lshrrev_b32 v21, 16, v70
    v_and_b32 v49, 0xffff0000, v70
    v_and_b32 v22, 0xffff, v71
    v_lshlrev_b32 v50, 16, v71
    v_lshrrev_b32 v23, 16, v71
    v_and_b32 v51, 0xffff0000, v71
    v_and_b32 v24, 0xffff, v72
    v_lshlrev_b32 v52, 16, v72
    v_lshrrev_b32 v25, 16, v72
    v_and_b32 v53, 0xffff0000, v72
    v_and_b32 v26, 0xffff, v73
    v_lshlrev_b32 v54, 16, v73
    v_lshrrev_b32 v27, 16, v73
    v_and_b32 v55, 0xffff0000, v73
    v_and_b32 v28, 0xffff, v74
    v_lshlrev_b32 v56, 16, v74
    v_lshrrev_b32 v29, 16, v74
    v_and_b32 v57, 0xffff0000, v74
    v_and_b32 v30, 0xffff, v75
    v_lshlrev_b32 v58, 16, v75
    v_lshrrev_b32 v31, 16, v75
    v_and_b32 v59, 0xffff0000, v75
    v_and_b32 v32, 0xffff, v76
    v_lshlrev_b32 v60, 16, v76
    v_lshrrev_b32 v33, 16, v76
    v_and_b32 v61, 0xffff0000, v76
    v_and_b32 v34, 0xffff, v77
    v_lshlrev_b32 v62, 16, v77
    v_lshrrev_b32 v35, 16, v77
    v_and_b32 v63, 0xffff0000, v77
    v_and_b32 v224, 0xff, v100
    v_cmp_eq_u32 vcc, 0xff, v224
    s_nop 1
    v_cndmask_b32 v224, v224, 0, vcc
    v_add_u32 v224, 1, v224
    s_mov_b32 s7, 0x01010101
    v_mul_lo_u32 v100, v224, s7
    ds_write_b32 v105, v224
    v_mov_b32 v107, 0x3f803f80
    v_mov_b32 v229, 0
    v_lshlrev_b32 v108, 16, v80
    v_and_b32 v109, 0xffff0000, v80
    v_mul_f32 v108, v108, v36
    v_mul_f32 v109, v109, v37
    v_cvt_pk_bf16_f32 v80, v108, v109
    v_lshlrev_b32 v108, 16, v81
    v_and_b32 v109, 0xffff0000, v81
    v_mul_f32 v108, v108, v38
    v_mul_f32 v109, v109, v39
    v_cvt_pk_bf16_f32 v81, v108, v109
    v_lshlrev_b32 v108, 16, v82
    v_and_b32 v109, 0xffff0000, v82
    v_mul_f32 v108, v108, v40
    v_mul_f32 v109, v109, v41
    v_cvt_pk_bf16_f32 v82, v108, v109
    v_lshlrev_b32 v108, 16, v83
    v_and_b32 v109, 0xffff0000, v83
    v_mul_f32 v108, v108, v42
    v_mul_f32 v109, v109, v43
    v_cvt_pk_bf16_f32 v83, v108, v109
    v_lshlrev_b32 v108, 16, v84
    v_and_b32 v109, 0xffff0000, v84
    v_mul_f32 v108, v108, v44
    v_mul_f32 v109, v109, v45
    v_cvt_pk_bf16_f32 v84, v108, v109
    v_lshlrev_b32 v108, 16, v85
    v_and_b32 v109, 0xffff0000, v85
    v_mul_f32 v108, v108, v46
    v_mul_f32 v109, v109, v47
    v_cvt_pk_bf16_f32 v85, v108, v109
    v_lshlrev_b32 v108, 16, v86
    v_and_b32 v109, 0xffff0000, v86
    v_mul_f32 v108, v108, v48
    v_mul_f32 v109, v109, v49
    v_cvt_pk_bf16_f32 v86, v108, v109
    v_lshlrev_b32 v108, 16, v87
    v_and_b32 v109, 0xffff0000, v87
    v_mul_f32 v108, v108, v50
    v_mul_f32 v109, v109, v51
    v_cvt_pk_bf16_f32 v87, v108, v109
    v_lshlrev_b32 v108, 16, v88
    v_and_b32 v109, 0xffff0000, v88
    v_mul_f32 v108, v108, v52
    v_mul_f32 v109, v109, v53
    v_cvt_pk_bf16_f32 v88, v108, v109
    v_lshlrev_b32 v108, 16, v89
    v_and_b32 v109, 0xffff0000, v89
    v_mul_f32 v108, v108, v54
    v_mul_f32 v109, v109, v55
    v_cvt_pk_bf16_f32 v89, v108, v109
    v_lshlrev_b32 v108, 16, v90
    v_and_b32 v109, 0xffff0000, v90
    v_mul_f32 v108, v108, v56
    v_mul_f32 v109, v109, v57
    v_cvt_pk_bf16_f32 v90, v108, v109
    v_lshlrev_b32 v108, 16, v91
    v_and_b32 v109, 0xffff0000, v91
    v_mul_f32 v108, v108, v58
    v_mul_f32 v109, v109, v59
    v_cvt_pk_bf16_f32 v91, v108, v109
    v_lshlrev_b32 v108, 16, v92
    v_and_b32 v109, 0xffff0000, v92
    v_mul_f32 v108, v108, v60
    v_mul_f32 v109, v109, v61
    v_cvt_pk_bf16_f32 v92, v108, v109
    v_lshlrev_b32 v108, 16, v93
    v_and_b32 v109, 0xffff0000, v93
    v_mul_f32 v108, v108, v62
    v_mul_f32 v109, v109, v63
    v_cvt_pk_bf16_f32 v93, v108, v109
    v_dot2_f32_bf16 v229, v80, v107, v229
    v_dot2_f32_bf16 v229, v81, v107, v229
    v_dot2_f32_bf16 v229, v82, v107, v229
    v_dot2_f32_bf16 v229, v83, v107, v229
    v_dot2_f32_bf16 v229, v84, v107, v229
    v_dot2_f32_bf16 v229, v85, v107, v229
    v_dot2_f32_bf16 v229, v86, v107, v229
    v_dot2_f32_bf16 v229, v87, v107, v229
    v_dot2_f32_bf16 v229, v88, v107, v229
    v_dot2_f32_bf16 v229, v89, v107, v229
    v_dot2_f32_bf16 v229, v90, v107, v229
    v_dot2_f32_bf16 v229, v91, v107, v229
    v_dot2_f32_bf16 v229, v92, v107, v229
    v_dot2_f32_bf16 v229, v93, v107, v229
    s_nop 2
    v_add_f32_dpp v229, v229, v229 row_ror:4 row_mask:0xf bank_mask:0xf
    s_nop 1
    v_add_f32_dpp v229, v229, v229 row_ror:8 row_mask:0xf bank_mask:0xf
    v_mov_b32 v108, v229
    s_nop 1
    v_permlane16_swap_b32 v229, v108
    v_add_f32 v229, v229, v108
    v_mov_b32 v108, v229
    s_nop 1
    v_permlane32_swap_b32 v229, v108
    v_add_f32 v229, v229, v108
    v_cvt_pk_bf16_f32 v229, v229, v229
    v_and_b32 v229, 0xffff0000, v229
    v_mul_f32 v229, 0xbfb8aa3b, v229
    v_exp_f32 v229, v229
    s_nop 0
    v_add_f32 v229, 1.0, v229
    v_rcp_f32 v229, v229
    s_nop 0
    v_cvt_pk_bf16_f32 v229, v229, v229
    v_and_b32 v229, 0xffff0000, v229
    v_sub_f32 v230, 1.0, v229
    v_cvt_pk_bf16_f32 v230, v230, v230
    v_and_b32 v230, 0xffff0000, v230
    ds_write_b32 v105, v229 offset:4
    s_sleep 80
L_pollQb:
    global_load_dwordx4 v[112:115], v106, s[40:41] sc1
    global_load_dwordx4 v[116:119], v106, s[40:41] offset:16 sc1
L_pollQwb:
    s_waitcnt vmcnt(0)
    v_xor_b32 v101, v113, v100
    v_xor_b32 v102, v115, v100
    v_xor_b32 v103, v117, v100
    v_xor_b32 v104, v119, v100
    v_or3_b32 v101, v101, v102, v103
    v_or_b32 v101, v101, v104
    v_cmp_ne_u32 vcc, 0, v101
    s_add_u32 s15, s15, 1
    s_cmp_ge_u32 s15, 65536
    s_cbranch_scc1 L_pollQ_doneb
    s_and_b64 exec, exec, vcc
    s_cbranch_scc0 L_pollQ_doneb
    s_sleep 8
    s_branch L_pollQb
L_pollQ_doneb:
    s_mov_b64 exec, -1
    v_mov_b32 v113, v114
    v_mov_b32 v114, v116
    v_mov_b32 v115, v118
    v_lshlrev_b32 v101, 4, v0
    ds_write_b128 v101, v[112:115]
    v_mov_b32 v102, 9344
    v_mov_b32 v103, 1
    ds_write_b32 v102, v103
    s_cmp_ge_u32 s9, 7
    s_cbranch_scc1 L_noffn
    s_waitcnt lgkmcnt(0)
    s_mov_b32 s11, 0
    buffer_load_dwordx4 v[112:115], v6, s[44:47], s11 offen nt
    s_mov_b32 s11, 3584
    buffer_load_dwordx4 v[116:119], v6, s[44:47], s11 offen nt
    s_mov_b32 s11, 7168
    buffer_load_dwordx4 v[120:123], v6, s[44:47], s11 offen nt
    s_mov_b32 s11, 10752
    buffer_load_dwordx4 v[124:127], v6, s[44:47], s11 offen nt
    s_mov_b32 s11, 14336
    buffer_load_dwordx4 v[128:131], v6, s[44:47], s11 offen nt
    s_mov_b32 s11, 17920
    buffer_load_dwordx4 v[132:135], v6, s[44:47], s11 offen nt
    s_mov_b32 s11, 21504
    buffer_load_dwordx4 v[136:139], v6, s[44:47], s11 offen nt
    s_mov_b32 s11, 25088
    buffer_load_dwordx4 v[140:143], v6, s[44:47], s11 offen nt
    s_mov_b32 s11, 28672
    buffer_load_dwordx4 v[144:147], v6, s[44:47], s11 offen nt
    s_mov_b32 s11, 32256
    buffer_load_dwordx4 v[148:151], v6, s[44:47], s11 offen nt
    s_mov_b32 s11, 35840
    buffer_load_dwordx4 v[152:155], v6, s[44:47], s11 offen nt
    s_mov_b32 s11, 39424
    buffer_load_dwordx4 v[156:159], v6, s[44:47], s11 offen nt
    s_mov_b32 s11, 43008
    buffer_load_dwordx4 v[160:163], v6, s[44:47], s11 offen nt
    s_mov_b32 s11, 46592
    buffer_load_dwordx4 v[164:167], v6, s[44:47], s11 offen nt
    s_mov_b32 s11, 50176
    buffer_load_dwordx4 v[168:171], v6, s[44:47], s11 offen nt
    s_mov_b32 s11, 53760
    buffer_load_dwordx4 v[172:175], v6, s[44:47], s11 offen nt
    s_mov_b32 s11, 57344
    buffer_load_dwordx4 v[176:179], v6, s[44:47], s11 offen nt
    s_mov_b32 s11, 60928
    buffer_load_dwordx4 v[180:183], v6, s[44:47], s11 offen nt
    s_mov_b32 s11, 64512
    buffer_load_dwordx4 v[184:187], v6, s[44:47], s11 offen nt
    s_mov_b32 s11, 68096
    buffer_load_dwordx4 v[188:191], v6, s[44:47], s11 offen nt
    s_mov_b32 s11, 71680
    buffer_load_dwordx4 v[192:195], v6, s[44:47], s11 offen nt
    s_mov_b32 s11, 75264
    buffer_load_dwordx4 v[196:199], v6, s[44:47], s11 offen nt
    s_mov_b32 s11, 78848
    buffer_load_dwordx4 v[200:203], v6, s[44:47], s11 offen nt
    s_mov_b32 s11, 82432
    buffer_load_dwordx4 v[204:207], v6, s[44:47], s11 offen nt
    s_mov_b32 s11, 86016
    buffer_load_dwordx4 v[208:211], v6, s[44:47], s11 offen nt
    s_mov_b32 s11, 89600
    buffer_load_dwordx4 v[212:215], v6, s[44:47], s11 offen nt
    s_mov_b32 s11, 93184
    buffer_load_dwordx4 v[216:219], v6, s[44:47], s11 offen nt
    s_mov_b32 s11, 96768
    buffer_load_dwordx4 v[220:223], v6, s[44:47], s11 offen nt
    v_mov_b32 v64, 0
    v_mov_b32 v65, 0
    v_mov_b32 v66, 0
    v_mov_b32 v67, 0
    v_mov_b32 v68, 0
    v_mov_b32 v69, 0
    v_mov_b32 v70, 0
    v_mov_b32 v71, 0
    v_mov_b32 v72, 0
    v_mov_b32 v73, 0
    v_mov_b32 v74, 0
    v_mov_b32 v75, 0
    v_mov_b32 v76, 0
    v_mov_b32 v77, 0
    v_mov_b32 v78, 0
    v_mov_b32 v79, 0
    v_mul_u32_u24 v1, 1792, v5
    v_lshl_add_u32 v1, v4, 4, v1
    s_mul_i32 s7, s8, 28672
    s_add_u32 s52, s32, s7
    s_addc_u32 s53, s33, 0
    s_sub_u32 s54, 1605632, s7
    s_mov_b32 s55, 0x00020000
    s_waitcnt vmcnt(27)
    v_dot2_f32_bf16 v64, v112, v8, v64
    v_dot2_f32_bf16 v65, v112, v36, v65
    v_dot2_f32_bf16 v66, v113, v8, v66
    v_dot2_f32_bf16 v67, v113, v36, v67
    v_dot2_f32_bf16 v68, v114, v8, v68
    v_dot2_f32_bf16 v69, v114, v36, v69
    v_dot2_f32_bf16 v70, v115, v8, v70
    v_dot2_f32_bf16 v71, v115, v36, v71
    s_mov_b32 s11, 0
    buffer_load_dwordx4 v[112:115], v6, s[48:51], s11 offen nt
    s_waitcnt vmcnt(27)
    v_dot2_f32_bf16 v64, v116, v9, v64
    v_dot2_f32_bf16 v65, v116, v37, v65
    v_dot2_f32_bf16 v66, v117, v9, v66
    v_dot2_f32_bf16 v67, v117, v37, v67
    v_dot2_f32_bf16 v68, v118, v9, v68
    v_dot2_f32_bf16 v69, v118, v37, v69
    v_dot2_f32_bf16 v70, v119, v9, v70
    v_dot2_f32_bf16 v71, v119, v37, v71
    s_mov_b32 s11, 3584
    buffer_load_dwordx4 v[116:119], v6, s[48:51], s11 offen nt
    s_waitcnt vmcnt(27)
    v_dot2_f32_bf16 v64, v120, v10, v64
    v_dot2_f32_bf16 v65, v120, v38, v65
    v_dot2_f32_bf16 v66, v121, v10, v66
    v_dot2_f32_bf16 v67, v121, v38, v67
    v_dot2_f32_bf16 v68, v122, v10, v68
    v_dot2_f32_bf16 v69, v122, v38, v69
    v_dot2_f32_bf16 v70, v123, v10, v70
    v_dot2_f32_bf16 v71, v123, v38, v71
    s_mov_b32 s11, 7168
    buffer_load_dwordx4 v[120:123], v6, s[48:51], s11 offen nt
    s_waitcnt vmcnt(27)
    v_dot2_f32_bf16 v64, v124, v11, v64
    v_dot2_f32_bf16 v65, v124, v39, v65
    v_dot2_f32_bf16 v66, v125, v11, v66
    v_dot2_f32_bf16 v67, v125, v39, v67
    v_dot2_f32_bf16 v68, v126, v11, v68
    v_dot2_f32_bf16 v69, v126, v39, v69
    v_dot2_f32_bf16 v70, v127, v11, v70
    v_dot2_f32_bf16 v71, v127, v39, v71
    s_mov_b32 s11, 10752
    buffer_load_dwordx4 v[124:127], v6, s[48:51], s11 offen nt
    s_waitcnt vmcnt(27)
    v_dot2_f32_bf16 v64, v128, v12, v64
    v_dot2_f32_bf16 v65, v128, v40, v65
    v_dot2_f32_bf16 v66, v129, v12, v66
    v_dot2_f32_bf16 v67, v129, v40, v67
    v_dot2_f32_bf16 v68, v130, v12, v68
    v_dot2_f32_bf16 v69, v130, v40, v69
    v_dot2_f32_bf16 v70, v131, v12, v70
    v_dot2_f32_bf16 v71, v131, v40, v71
    s_mov_b32 s11, 14336
    buffer_load_dwordx4 v[128:131], v6, s[48:51], s11 offen nt
    s_waitcnt vmcnt(27)
    v_dot2_f32_bf16 v64, v132, v13, v64
    v_dot2_f32_bf16 v65, v132, v41, v65
    v_dot2_f32_bf16 v66, v133, v13, v66
    v_dot2_f32_bf16 v67, v133, v41, v67
    v_dot2_f32_bf16 v68, v134, v13, v68
    v_dot2_f32_bf16 v69, v134, v41, v69
    v_dot2_f32_bf16 v70, v135, v13, v70
    v_dot2_f32_bf16 v71, v135, v41, v71
    s_mov_b32 s11, 17920
    buffer_load_dwordx4 v[132:135], v6, s[48:51], s11 offen nt
    s_waitcnt vmcnt(27)
    v_dot2_f32_bf16 v64, v136, v14, v64
    v_dot2_f32_bf16 v65, v136, v42, v65
    v_dot2_f32_bf16 v66, v137, v14, v66
    v_dot2_f32_bf16 v67, v137, v42, v67
    v_dot2_f32_bf16 v68, v138, v14, v68
    v_dot2_f32_bf16 v69, v138, v42, v69
    v_dot2_f32_bf16 v70, v139, v14, v70
    v_dot2_f32_bf16 v71, v139, v42, v71
    s_mov_b32 s11, 21504
    buffer_load_dwordx4 v[136:139], v6, s[48:51], s11 offen nt
    s_waitcnt vmcnt(27)
    v_dot2_f32_bf16 v64, v140, v15, v64
    v_dot2_f32_bf16 v65, v140, v43, v65
    v_dot2_f32_bf16 v66, v141, v15, v66
    v_dot2_f32_bf16 v67, v141, v43, v67
    v_dot2_f32_bf16 v68, v142, v15, v68
    v_dot2_f32_bf16 v69, v142, v43, v69
    v_dot2_f32_bf16 v70, v143, v15, v70
    v_dot2_f32_bf16 v71, v143, v43, v71
    s_mov_b32 s11, 25088
    buffer_load_dwordx4 v[140:143], v6, s[48:51], s11 offen nt
    s_waitcnt vmcnt(27)
    v_dot2_f32_bf16 v64, v144, v16, v64
    v_dot2_f32_bf16 v65, v144, v44, v65
    v_dot2_f32_bf16 v66, v145, v16, v66
    v_dot2_f32_bf16 v67, v145, v44, v67
    v_dot2_f32_bf16 v68, v146, v16, v68
    v_dot2_f32_bf16 v69, v146, v44, v69
    v_dot2_f32_bf16 v70, v147, v16, v70
    v_dot2_f32_bf16 v71, v147, v44, v71
    s_mov_b32 s11, 28672
    buffer_load_dwordx4 v[144:147], v6, s[48:51], s11 offen nt
    s_waitcnt vmcnt(27)
    v_dot2_f32_bf16 v64, v148, v17, v64
    v_dot2_f32_bf16 v65, v148, v45, v65
    v_dot2_f32_bf16 v66, v149, v17, v66
    v_dot2_f32_bf16 v67, v149, v45, v67
    v_dot2_f32_bf16 v68, v150, v17, v68
    v_dot2_f32_bf16 v69, v150, v45, v69
    v_dot2_f32_bf16 v70, v151, v17, v70
    v_dot2_f32_bf16 v71, v151, v45, v71
    s_mov_b32 s11, 32256
    buffer_load_dwordx4 v[148:151], v6, s[48:51], s11 offen nt
    s_waitcnt vmcnt(27)
    v_dot2_f32_bf16 v64, v152, v18, v64
    v_dot2_f32_bf16 v65, v152, v46, v65
    v_dot2_f32_bf16 v66, v153, v18, v66
    v_dot2_f32_bf16 v67, v153, v46, v67
    v_dot2_f32_bf16 v68, v154, v18, v68
    v_dot2_f32_bf16 v69, v154, v46, v69
    v_dot2_f32_bf16 v70, v155, v18, v70
    v_dot2_f32_bf16 v71, v155, v46, v71
    s_mov_b32 s11, 35840
    buffer_load_dwordx4 v[152:155], v6, s[48:51], s11 offen nt
    s_waitcnt vmcnt(27)
    v_dot2_f32_bf16 v64, v156, v19, v64
    v_dot2_f32_bf16 v65, v156, v47, v65
    v_dot2_f32_bf16 v66, v157, v19, v66
    v_dot2_f32_bf16 v67, v157, v47, v67
    v_dot2_f32_bf16 v68, v158, v19, v68
    v_dot2_f32_bf16 v69, v158, v47, v69
    v_dot2_f32_bf16 v70, v159, v19, v70
    v_dot2_f32_bf16 v71, v159, v47, v71
    s_mov_b32 s11, 39424
    buffer_load_dwordx4 v[156:159], v6, s[48:51], s11 offen nt
    s_waitcnt vmcnt(27)
    v_dot2_f32_bf16 v64, v160, v20, v64
    v_dot2_f32_bf16 v65, v160, v48, v65
    v_dot2_f32_bf16 v66, v161, v20, v66
    v_dot2_f32_bf16 v67, v161, v48, v67
    v_dot2_f32_bf16 v68, v162, v20, v68
    v_dot2_f32_bf16 v69, v162, v48, v69
    v_dot2_f32_bf16 v70, v163, v20, v70
    v_dot2_f32_bf16 v71, v163, v48, v71
    s_mov_b32 s11, 43008
    buffer_load_dwordx4 v[160:163], v6, s[48:51], s11 offen nt
    s_waitcnt vmcnt(27)
    v_dot2_f32_bf16 v64, v164, v21, v64
    v_dot2_f32_bf16 v65, v164, v49, v65
    v_dot2_f32_bf16 v66, v165, v21, v66
    v_dot2_f32_bf16 v67, v165, v49, v67
    v_dot2_f32_bf16 v68, v166, v21, v68
    v_dot2_f32_bf16 v69, v166, v49, v69
    v_dot2_f32_bf16 v70, v167, v21, v70
    v_dot2_f32_bf16 v71, v167, v49, v71
    s_mov_b32 s11, 46592
    buffer_load_dwordx4 v[164:167], v6, s[48:51], s11 offen nt
    s_waitcnt vmcnt(27)
    v_dot2_f32_bf16 v64, v168, v22, v64
    v_dot2_f32_bf16 v65, v168, v50, v65
    v_dot2_f32_bf16 v66, v169, v22, v66
    v_dot2_f32_bf16 v67, v169, v50, v67
    v_dot2_f32_bf16 v68, v170, v22, v68
    v_dot2_f32_bf16 v69, v170, v50, v69
    v_dot2_f32_bf16 v70, v171, v22, v70
    v_dot2_f32_bf16 v71, v171, v50, v71
    s_mov_b32 s11, 50176
    buffer_load_dwordx4 v[168:171], v6, s[48:51], s11 offen nt
    s_waitcnt vmcnt(27)
    v_dot2_f32_bf16 v64, v172, v23, v64
    v_dot2_f32_bf16 v65, v172, v51, v65
    v_dot2_f32_bf16 v66, v173, v23, v66
    v_dot2_f32_bf16 v67, v173, v51, v67
    v_dot2_f32_bf16 v68, v174, v23, v68
    v_dot2_f32_bf16 v69, v174, v51, v69
    v_dot2_f32_bf16 v70, v175, v23, v70
    v_dot2_f32_bf16 v71, v175, v51, v71
    s_mov_b32 s11, 53760
    buffer_load_dwordx4 v[172:175], v6, s[48:51], s11 offen nt
    s_waitcnt vmcnt(27)
    v_dot2_f32_bf16 v64, v176, v24, v64
    v_dot2_f32_bf16 v65, v176, v52, v65
    v_dot2_f32_bf16 v66, v177, v24, v66
    v_dot2_f32_bf16 v67, v177, v52, v67
    v_dot2_f32_bf16 v68, v178, v24, v68
    v_dot2_f32_bf16 v69, v178, v52, v69
    v_dot2_f32_bf16 v70, v179, v24, v70
    v_dot2_f32_bf16 v71, v179, v52, v71
    s_mov_b32 s11, 57344
    buffer_load_dwordx4 v[176:179], v6, s[48:51], s11 offen nt
    s_waitcnt vmcnt(27)
    v_dot2_f32_bf16 v64, v180, v25, v64
    v_dot2_f32_bf16 v65, v180, v53, v65
    v_dot2_f32_bf16 v66, v181, v25, v66
    v_dot2_f32_bf16 v67, v181, v53, v67
    v_dot2_f32_bf16 v68, v182, v25, v68
    v_dot2_f32_bf16 v69, v182, v53, v69
    v_dot2_f32_bf16 v70, v183, v25, v70
    v_dot2_f32_bf16 v71, v183, v53, v71
    s_mov_b32 s11, 60928
    buffer_load_dwordx4 v[180:183], v6, s[48:51], s11 offen nt
    s_waitcnt vmcnt(27)
    v_dot2_f32_bf16 v64, v184, v26, v64
    v_dot2_f32_bf16 v65, v184, v54, v65
    v_dot2_f32_bf16 v66, v185, v26, v66
    v_dot2_f32_bf16 v67, v185, v54, v67
    v_dot2_f32_bf16 v68, v186, v26, v68
    v_dot2_f32_bf16 v69, v186, v54, v69
    v_dot2_f32_bf16 v70, v187, v26, v70
    v_dot2_f32_bf16 v71, v187, v54, v71
    s_mov_b32 s11, 64512
    buffer_load_dwordx4 v[184:187], v6, s[48:51], s11 offen nt
    s_waitcnt vmcnt(27)
    v_dot2_f32_bf16 v64, v188, v27, v64
    v_dot2_f32_bf16 v65, v188, v55, v65
    v_dot2_f32_bf16 v66, v189, v27, v66
    v_dot2_f32_bf16 v67, v189, v55, v67
    v_dot2_f32_bf16 v68, v190, v27, v68
    v_dot2_f32_bf16 v69, v190, v55, v69
    v_dot2_f32_bf16 v70, v191, v27, v70
    v_dot2_f32_bf16 v71, v191, v55, v71
    s_mov_b32 s11, 68096
    buffer_load_dwordx4 v[188:191], v6, s[48:51], s11 offen nt
    s_waitcnt vmcnt(27)
    v_dot2_f32_bf16 v64, v192, v28, v64
    v_dot2_f32_bf16 v65, v192, v56, v65
    v_dot2_f32_bf16 v66, v193, v28, v66
    v_dot2_f32_bf16 v67, v193, v56, v67
    v_dot2_f32_bf16 v68, v194, v28, v68
    v_dot2_f32_bf16 v69, v194, v56, v69
    v_dot2_f32_bf16 v70, v195, v28, v70
    v_dot2_f32_bf16 v71, v195, v56, v71
    s_mov_b32 s11, 71680
    buffer_load_dwordx4 v[192:195], v6, s[48:51], s11 offen nt
    s_waitcnt vmcnt(27)
    v_dot2_f32_bf16 v64, v196, v29, v64
    v_dot2_f32_bf16 v65, v196, v57, v65
    v_dot2_f32_bf16 v66, v197, v29, v66
    v_dot2_f32_bf16 v67, v197, v57, v67
    v_dot2_f32_bf16 v68, v198, v29, v68
    v_dot2_f32_bf16 v69, v198, v57, v69
    v_dot2_f32_bf16 v70, v199, v29, v70
    v_dot2_f32_bf16 v71, v199, v57, v71
    s_mov_b32 s11, 75264
    buffer_load_dwordx4 v[196:199], v6, s[48:51], s11 offen nt
    s_waitcnt vmcnt(27)
    v_dot2_f32_bf16 v64, v200, v30, v64
    v_dot2_f32_bf16 v65, v200, v58, v65
    v_dot2_f32_bf16 v66, v201, v30, v66
    v_dot2_f32_bf16 v67, v201, v58, v67
    v_dot2_f32_bf16 v68, v202, v30, v68
    v_dot2_f32_bf16 v69, v202, v58, v69
    v_dot2_f32_bf16 v70, v203, v30, v70
    v_dot2_f32_bf16 v71, v203, v58, v71
    s_mov_b32 s11, 78848
    buffer_load_dwordx4 v[200:203], v6, s[48:51], s11 offen nt
    s_waitcnt vmcnt(27)
    v_dot2_f32_bf16 v64, v204, v31, v64
    v_dot2_f32_bf16 v65, v204, v59, v65
    v_dot2_f32_bf16 v66, v205, v31, v66
    v_dot2_f32_bf16 v67, v205, v59, v67
    v_dot2_f32_bf16 v68, v206, v31, v68
    v_dot2_f32_bf16 v69, v206, v59, v69
    v_dot2_f32_bf16 v70, v207, v31, v70
    v_dot2_f32_bf16 v71, v207, v59, v71
    s_mov_b32 s11, 82432
    buffer_load_dwordx4 v[204:207], v6, s[48:51], s11 offen nt
    s_waitcnt vmcnt(27)
    v_dot2_f32_bf16 v64, v208, v32, v64
    v_dot2_f32_bf16 v65, v208, v60, v65
    v_dot2_f32_bf16 v66, v209, v32, v66
    v_dot2_f32_bf16 v67, v209, v60, v67
    v_dot2_f32_bf16 v68, v210, v32, v68
    v_dot2_f32_bf16 v69, v210, v60, v69
    v_dot2_f32_bf16 v70, v211, v32, v70
    v_dot2_f32_bf16 v71, v211, v60, v71
    s_mov_b32 s11, 86016
    buffer_load_dwordx4 v[208:211], v6, s[48:51], s11 offen nt
    s_waitcnt vmcnt(27)
    v_dot2_f32_bf16 v64, v212, v33, v64
    v_dot2_f32_bf16 v65, v212, v61, v65
    v_dot2_f32_bf16 v66, v213, v33, v66
    v_dot2_f32_bf16 v67, v213, v61, v67
    v_dot2_f32_bf16 v68, v214, v33, v68
    v_dot2_f32_bf16 v69, v214, v61, v69
    v_dot2_f32_bf16 v70, v215, v33, v70
    v_dot2_f32_bf16 v71, v215, v61, v71
    s_mov_b32 s11, 89600
    buffer_load_dwordx4 v[212:215], v6, s[48:51], s11 offen nt
    s_waitcnt vmcnt(27)
    v_dot2_f32_bf16 v64, v216, v34, v64
    v_dot2_f32_bf16 v65, v216, v62, v65
    v_dot2_f32_bf16 v66, v217, v34, v66
    v_dot2_f32_bf16 v67, v217, v62, v67
    v_dot2_f32_bf16 v68, v218, v34, v68
    v_dot2_f32_bf16 v69, v218, v62, v69
    v_dot2_f32_bf16 v70, v219, v34, v70
    v_dot2_f32_bf16 v71, v219, v62, v71
    s_mov_b32 s11, 93184
    buffer_load_dwordx4 v[216:219], v6, s[48:51], s11 offen nt
    s_waitcnt vmcnt(27)
    v_dot2_f32_bf16 v64, v220, v35, v64
    v_dot2_f32_bf16 v65, v220, v63, v65
    v_dot2_f32_bf16 v66, v221, v35, v66
    v_dot2_f32_bf16 v67, v221, v63, v67
    v_dot2_f32_bf16 v68, v222, v35, v68
    v_dot2_f32_bf16 v69, v222, v63, v69
    v_dot2_f32_bf16 v70, v223, v35, v70
    v_dot2_f32_bf16 v71, v223, v63, v71
    s_mov_b32 s11, 96768
    buffer_load_dwordx4 v[220:223], v6, s[48:51], s11 offen nt
    s_waitcnt vmcnt(27)
    v_dot2_f32_bf16 v72, v112, v8, v72
    v_dot2_f32_bf16 v73, v112, v36, v73
    v_dot2_f32_bf16 v74, v113, v8, v74
    v_dot2_f32_bf16 v75, v113, v36, v75
    v_dot2_f32_bf16 v76, v114, v8, v76
    v_dot2_f32_bf16 v77, v114, v36, v77
    v_dot2_f32_bf16 v78, v115, v8, v78
    v_dot2_f32_bf16 v79, v115, v36, v79
    s_waitcnt vmcnt(26)
    v_dot2_f32_bf16 v72, v116, v9, v72
    v_dot2_f32_bf16 v73, v116, v37, v73
    v_dot2_f32_bf16 v74, v117, v9, v74
    v_dot2_f32_bf16 v75, v117, v37, v75
    v_dot2_f32_bf16 v76, v118, v9, v76
    v_dot2_f32_bf16 v77, v118, v37, v77
    v_dot2_f32_bf16 v78, v119, v9, v78
    v_dot2_f32_bf16 v79, v119, v37, v79
    s_waitcnt vmcnt(25)
    v_dot2_f32_bf16 v72, v120, v10, v72
    v_dot2_f32_bf16 v73, v120, v38, v73
    v_dot2_f32_bf16 v74, v121, v10, v74
    v_dot2_f32_bf16 v75, v121, v38, v75
    v_dot2_f32_bf16 v76, v122, v10, v76
    v_dot2_f32_bf16 v77, v122, v38, v77
    v_dot2_f32_bf16 v78, v123, v10, v78
    v_dot2_f32_bf16 v79, v123, v38, v79
    s_waitcnt vmcnt(24)
    v_dot2_f32_bf16 v72, v124, v11, v72
    v_dot2_f32_bf16 v73, v124, v39, v73
    v_dot2_f32_bf16 v74, v125, v11, v74
    v_dot2_f32_bf16 v75, v125, v39, v75
    v_dot2_f32_bf16 v76, v126, v11, v76
    v_dot2_f32_bf16 v77, v126, v39, v77
    v_dot2_f32_bf16 v78, v127, v11, v78
    v_dot2_f32_bf16 v79, v127, v39, v79
    s_waitcnt vmcnt(23)
    v_dot2_f32_bf16 v72, v128, v12, v72
    v_dot2_f32_bf16 v73, v128, v40, v73
    v_dot2_f32_bf16 v74, v129, v12, v74
    v_dot2_f32_bf16 v75, v129, v40, v75
    v_dot2_f32_bf16 v76, v130, v12, v76
    v_dot2_f32_bf16 v77, v130, v40, v77
    v_dot2_f32_bf16 v78, v131, v12, v78
    v_dot2_f32_bf16 v79, v131, v40, v79
    s_waitcnt vmcnt(22)
    v_dot2_f32_bf16 v72, v132, v13, v72
    v_dot2_f32_bf16 v73, v132, v41, v73
    v_dot2_f32_bf16 v74, v133, v13, v74
    v_dot2_f32_bf16 v75, v133, v41, v75
    v_dot2_f32_bf16 v76, v134, v13, v76
    v_dot2_f32_bf16 v77, v134, v41, v77
    v_dot2_f32_bf16 v78, v135, v13, v78
    v_dot2_f32_bf16 v79, v135, v41, v79
    s_waitcnt vmcnt(21)
    v_dot2_f32_bf16 v72, v136, v14, v72
    v_dot2_f32_bf16 v73, v136, v42, v73
    v_dot2_f32_bf16 v74, v137, v14, v74
    v_dot2_f32_bf16 v75, v137, v42, v75
    v_dot2_f32_bf16 v76, v138, v14, v76
    v_dot2_f32_bf16 v77, v138, v42, v77
    v_dot2_f32_bf16 v78, v139, v14, v78
    v_dot2_f32_bf16 v79, v139, v42, v79
    s_waitcnt vmcnt(20)
    v_dot2_f32_bf16 v72, v140, v15, v72
    v_dot2_f32_bf16 v73, v140, v43, v73
    v_dot2_f32_bf16 v74, v141, v15, v74
    v_dot2_f32_bf16 v75, v141, v43, v75
    v_dot2_f32_bf16 v76, v142, v15, v76
    v_dot2_f32_bf16 v77, v142, v43, v77
    v_dot2_f32_bf16 v78, v143, v15, v78
    v_dot2_f32_bf16 v79, v143, v43, v79
    s_waitcnt vmcnt(19)
    v_dot2_f32_bf16 v72, v144, v16, v72
    v_dot2_f32_bf16 v73, v144, v44, v73
    v_dot2_f32_bf16 v74, v145, v16, v74
    v_dot2_f32_bf16 v75, v145, v44, v75
    v_dot2_f32_bf16 v76, v146, v16, v76
    v_dot2_f32_bf16 v77, v146, v44, v77
    v_dot2_f32_bf16 v78, v147, v16, v78
    v_dot2_f32_bf16 v79, v147, v44, v79
    s_waitcnt vmcnt(18)
    v_dot2_f32_bf16 v72, v148, v17, v72
    v_dot2_f32_bf16 v73, v148, v45, v73
    v_dot2_f32_bf16 v74, v149, v17, v74
    v_dot2_f32_bf16 v75, v149, v45, v75
    v_dot2_f32_bf16 v76, v150, v17, v76
    v_dot2_f32_bf16 v77, v150, v45, v77
    v_dot2_f32_bf16 v78, v151, v17, v78
    v_dot2_f32_bf16 v79, v151, v45, v79
    s_waitcnt vmcnt(17)
    v_dot2_f32_bf16 v72, v152, v18, v72
    v_dot2_f32_bf16 v73, v152, v46, v73
    v_dot2_f32_bf16 v74, v153, v18, v74
    v_dot2_f32_bf16 v75, v153, v46, v75
    v_dot2_f32_bf16 v76, v154, v18, v76
    v_dot2_f32_bf16 v77, v154, v46, v77
    v_dot2_f32_bf16 v78, v155, v18, v78
    v_dot2_f32_bf16 v79, v155, v46, v79
    s_waitcnt vmcnt(16)
    v_dot2_f32_bf16 v72, v156, v19, v72
    v_dot2_f32_bf16 v73, v156, v47, v73
    v_dot2_f32_bf16 v74, v157, v19, v74
    v_dot2_f32_bf16 v75, v157, v47, v75
    v_dot2_f32_bf16 v76, v158, v19, v76
    v_dot2_f32_bf16 v77, v158, v47, v77
    v_dot2_f32_bf16 v78, v159, v19, v78
    v_dot2_f32_bf16 v79, v159, v47, v79
    s_waitcnt vmcnt(15)
    v_dot2_f32_bf16 v72, v160, v20, v72
    v_dot2_f32_bf16 v73, v160, v48, v73
    v_dot2_f32_bf16 v74, v161, v20, v74
    v_dot2_f32_bf16 v75, v161, v48, v75
    v_dot2_f32_bf16 v76, v162, v20, v76
    v_dot2_f32_bf16 v77, v162, v48, v77
    v_dot2_f32_bf16 v78, v163, v20, v78
    v_dot2_f32_bf16 v79, v163, v48, v79
    s_waitcnt vmcnt(14)
    v_dot2_f32_bf16 v72, v164, v21, v72
    v_dot2_f32_bf16 v73, v164, v49, v73
    v_dot2_f32_bf16 v74, v165, v21, v74
    v_dot2_f32_bf16 v75, v165, v49, v75
    v_dot2_f32_bf16 v76, v166, v21, v76
    v_dot2_f32_bf16 v77, v166, v49, v77
    v_dot2_f32_bf16 v78, v167, v21, v78
    v_dot2_f32_bf16 v79, v167, v49, v79
    s_waitcnt vmcnt(13)
    v_dot2_f32_bf16 v72, v168, v22, v72
    v_dot2_f32_bf16 v73, v168, v50, v73
    v_dot2_f32_bf16 v74, v169, v22, v74
    v_dot2_f32_bf16 v75, v169, v50, v75
    v_dot2_f32_bf16 v76, v170, v22, v76
    v_dot2_f32_bf16 v77, v170, v50, v77
    v_dot2_f32_bf16 v78, v171, v22, v78
    v_dot2_f32_bf16 v79, v171, v50, v79
    s_waitcnt vmcnt(12)
    v_dot2_f32_bf16 v72, v172, v23, v72
    v_dot2_f32_bf16 v73, v172, v51, v73
    v_dot2_f32_bf16 v74, v173, v23, v74
    v_dot2_f32_bf16 v75, v173, v51, v75
    v_dot2_f32_bf16 v76, v174, v23, v76
    v_dot2_f32_bf16 v77, v174, v51, v77
    v_dot2_f32_bf16 v78, v175, v23, v78
    v_dot2_f32_bf16 v79, v175, v51, v79
    s_waitcnt vmcnt(11)
    v_dot2_f32_bf16 v72, v176, v24, v72
    v_dot2_f32_bf16 v73, v176, v52, v73
    v_dot2_f32_bf16 v74, v177, v24, v74
    v_dot2_f32_bf16 v75, v177, v52, v75
    v_dot2_f32_bf16 v76, v178, v24, v76
    v_dot2_f32_bf16 v77, v178, v52, v77
    v_dot2_f32_bf16 v78, v179, v24, v78
    v_dot2_f32_bf16 v79, v179, v52, v79
    s_waitcnt vmcnt(10)
    v_dot2_f32_bf16 v72, v180, v25, v72
    v_dot2_f32_bf16 v73, v180, v53, v73
    v_dot2_f32_bf16 v74, v181, v25, v74
    v_dot2_f32_bf16 v75, v181, v53, v75
    v_dot2_f32_bf16 v76, v182, v25, v76
    v_dot2_f32_bf16 v77, v182, v53, v77
    v_dot2_f32_bf16 v78, v183, v25, v78
    v_dot2_f32_bf16 v79, v183, v53, v79
    s_waitcnt vmcnt(9)
    v_dot2_f32_bf16 v72, v184, v26, v72
    v_dot2_f32_bf16 v73, v184, v54, v73
    v_dot2_f32_bf16 v74, v185, v26, v74
    v_dot2_f32_bf16 v75, v185, v54, v75
    v_dot2_f32_bf16 v76, v186, v26, v76
    v_dot2_f32_bf16 v77, v186, v54, v77
    v_dot2_f32_bf16 v78, v187, v26, v78
    v_dot2_f32_bf16 v79, v187, v54, v79
    s_waitcnt vmcnt(8)
    v_dot2_f32_bf16 v72, v188, v27, v72
    v_dot2_f32_bf16 v73, v188, v55, v73
    v_dot2_f32_bf16 v74, v189, v27, v74
    v_dot2_f32_bf16 v75, v189, v55, v75
    v_dot2_f32_bf16 v76, v190, v27, v76
    v_dot2_f32_bf16 v77, v190, v55, v77
    v_dot2_f32_bf16 v78, v191, v27, v78
    v_dot2_f32_bf16 v79, v191, v55, v79
    s_waitcnt vmcnt(7)
    v_dot2_f32_bf16 v72, v192, v28, v72
    v_dot2_f32_bf16 v73, v192, v56, v73
    v_dot2_f32_bf16 v74, v193, v28, v74
    v_dot2_f32_bf16 v75, v193, v56, v75
    v_dot2_f32_bf16 v76, v194, v28, v76
    v_dot2_f32_bf16 v77, v194, v56, v77
    v_dot2_f32_bf16 v78, v195, v28, v78
    v_dot2_f32_bf16 v79, v195, v56, v79
    s_waitcnt vmcnt(6)
    v_dot2_f32_bf16 v72, v196, v29, v72
    v_dot2_f32_bf16 v73, v196, v57, v73
    v_dot2_f32_bf16 v74, v197, v29, v74
    v_dot2_f32_bf16 v75, v197, v57, v75
    v_dot2_f32_bf16 v76, v198, v29, v76
    v_dot2_f32_bf16 v77, v198, v57, v77
    v_dot2_f32_bf16 v78, v199, v29, v78
    v_dot2_f32_bf16 v79, v199, v57, v79
    s_waitcnt vmcnt(5)
    v_dot2_f32_bf16 v72, v200, v30, v72
    v_dot2_f32_bf16 v73, v200, v58, v73
    v_dot2_f32_bf16 v74, v201, v30, v74
    v_dot2_f32_bf16 v75, v201, v58, v75
    v_dot2_f32_bf16 v76, v202, v30, v76
    v_dot2_f32_bf16 v77, v202, v58, v77
    v_dot2_f32_bf16 v78, v203, v30, v78
    v_dot2_f32_bf16 v79, v203, v58, v79
    s_waitcnt vmcnt(4)
    v_dot2_f32_bf16 v72, v204, v31, v72
    v_dot2_f32_bf16 v73, v204, v59, v73
    v_dot2_f32_bf16 v74, v205, v31, v74
    v_dot2_f32_bf16 v75, v205, v59, v75
    v_dot2_f32_bf16 v76, v206, v31, v76
    v_dot2_f32_bf16 v77, v206, v59, v77
    v_dot2_f32_bf16 v78, v207, v31, v78
    v_dot2_f32_bf16 v79, v207, v59, v79
    s_waitcnt vmcnt(3)
    v_dot2_f32_bf16 v72, v208, v32, v72
    v_dot2_f32_bf16 v73, v208, v60, v73
    v_dot2_f32_bf16 v74, v209, v32, v74
    v_dot2_f32_bf16 v75, v209, v60, v75
    v_dot2_f32_bf16 v76, v210, v32, v76
    v_dot2_f32_bf16 v77, v210, v60, v77
    v_dot2_f32_bf16 v78, v211, v32, v78
    v_dot2_f32_bf16 v79, v211, v60, v79
    s_waitcnt vmcnt(2)
    v_dot2_f32_bf16 v72, v212, v33, v72
    v_dot2_f32_bf16 v73, v212, v61, v73
    v_dot2_f32_bf16 v74, v213, v33, v74
    v_dot2_f32_bf16 v75, v213, v61, v75
    v_dot2_f32_bf16 v76, v214, v33, v76
    v_dot2_f32_bf16 v77, v214, v61, v77
    v_dot2_f32_bf16 v78, v215, v33, v78
    v_dot2_f32_bf16 v79, v215, v61, v79
    s_waitcnt vmcnt(1)
    v_dot2_f32_bf16 v72, v216, v34, v72
    v_dot2_f32_bf16 v73, v216, v62, v73
    v_dot2_f32_bf16 v74, v217, v34, v74
    v_dot2_f32_bf16 v75, v217, v62, v75
    v_dot2_f32_bf16 v76, v218, v34, v76
    v_dot2_f32_bf16 v77, v218, v62, v77
    v_dot2_f32_bf16 v78, v219, v34, v78
    v_dot2_f32_bf16 v79, v219, v62, v79
    s_waitcnt vmcnt(0)
    v_dot2_f32_bf16 v72, v220, v35, v72
    v_dot2_f32_bf16 v73, v220, v63, v73
    v_dot2_f32_bf16 v74, v221, v35, v74
    v_dot2_f32_bf16 v75, v221, v63, v75
    v_dot2_f32_bf16 v76, v222, v35, v76
    v_dot2_f32_bf16 v77, v222, v63, v77
    v_dot2_f32_bf16 v78, v223, v35, v78
    v_dot2_f32_bf16 v79, v223, v63, v79
    v_permlane32_swap_b32 v64, v68
    v_permlane32_swap_b32 v72, v76
    v_permlane32_swap_b32 v65, v69
    v_permlane32_swap_b32 v73, v77
    v_permlane32_swap_b32 v66, v70
    v_permlane32_swap_b32 v74, v78
    v_permlane32_swap_b32 v67, v71
    v_permlane32_swap_b32 v75, v79
    v_add_f32 v64, v64, v68
    v_add_f32 v72, v72, v76
    v_add_f32 v65, v65, v69
    v_add_f32 v73, v73, v77
    v_add_f32 v66, v66, v70
    v_add_f32 v74, v74, v78
    v_add_f32 v67, v67, v71
    v_add_f32 v75, v75, v79
    v_permlane16_swap_b32 v64, v66
    v_permlane16_swap_b32 v72, v74
    v_permlane16_swap_b32 v65, v67
    v_permlane16_swap_b32 v73, v75
    v_add_f32 v64, v64, v66
    v_add_f32 v72, v72, v74
    v_add_f32 v65, v65, v67
    v_add_f32 v73, v73, v75
    v_add_f32_dpp v64, v64, v64 row_ror:8 row_mask:0xf bank_mask:0x3
    v_add_f32_dpp v72, v72, v72 row_ror:8 row_mask:0xf bank_mask:0x3
    s_nop 0
    v_add_f32_dpp v64, v65, v65 row_ror:8 row_mask:0xf bank_mask:0xc
    v_add_f32_dpp v72, v73, v73 row_ror:8 row_mask:0xf bank_mask:0xc
    s_nop 0
    v_add_f32_dpp v64, v64, v64 row_shl:4 row_mask:0xf bank_mask:0x5
    v_add_f32_dpp v72, v72, v72 row_shl:4 row_mask:0xf bank_mask:0x5
    v_cvt_pk_bf16_f32 v64, v64, v64
    v_and_b32 v64, 0xffff0000, v64
    v_cvt_pk_bf16_f32 v72, v72, v72
    v_and_b32 v72, 0xffff0000, v72
    v_mul_f32 v8, v64, v64
    v_mul_f32 v8, v8, v64
    v_mov_b32 v9, 0x3d372713
    v_fma_f32 v8, v8, v9, v64
    v_mul_f32 v8, 0xc0135761, v8
    v_exp_f32 v8, v8
    s_nop 0
    v_add_f32 v8, 1.0, v8
    v_rcp_f32 v8, v8
    s_nop 0
    v_mul_f32 v64, v64, v8
    v_cvt_pk_bf16_f32 v64, v64, v64
    v_and_b32 v64, 0xffff0000, v64
    v_mul_f32 v64, v64, v72
    v_cvt_pk_bf16_f32 v64, v64, v64
    s_nop 1
    v_mov_b32_dpp v8, v64 row_newbcast:0 row_mask:0xf bank_mask:0xf
    v_mov_b32_dpp v9, v64 row_newbcast:8 row_mask:0xf bank_mask:0xf
    v_mov_b32_dpp v10, v64 row_newbcast:1 row_mask:0xf bank_mask:0xf
    v_mov_b32_dpp v11, v64 row_newbcast:9 row_mask:0xf bank_mask:0xf
    v_mov_b32_dpp v12, v64 row_newbcast:2 row_mask:0xf bank_mask:0xf
    v_mov_b32_dpp v13, v64 row_newbcast:10 row_mask:0xf bank_mask:0xf
    v_mov_b32_dpp v14, v64 row_newbcast:3 row_mask:0xf bank_mask:0xf
    v_mov_b32_dpp v15, v64 row_newbcast:11 row_mask:0xf bank_mask:0xf
    v_and_b32 v164, v8, v232
    v_and_b32 v165, v8, v233
    v_and_b32 v166, v8, v234
    v_and_b32 v167, v8, v235
    v_and_b32 v168, v9, v232
    v_and_b32 v169, v9, v233
    v_and_b32 v170, v9, v234
    v_and_b32 v171, v9, v235
    v_and_b32 v172, v10, v232
    v_and_b32 v173, v10, v233
    v_and_b32 v174, v10, v234
    v_and_b32 v175, v10, v235
    v_and_b32 v176, v11, v232
    v_and_b32 v177, v11, v233
    v_and_b32 v178, v11, v234
    v_and_b32 v179, v11, v235
    v_and_b32 v180, v12, v232
    v_and_b32 v181, v12, v233
    v_and_b32 v182, v12, v234
    v_and_b32 v183, v12, v235
    v_and_b32 v184, v13, v232
    v_and_b32 v185, v13, v233
    v_and_b32 v186, v13, v234
    v_and_b32 v187, v13, v235
    v_and_b32 v188, v14, v232
    v_and_b32 v189, v14, v233
    v_and_b32 v190, v14, v234
    v_and_b32 v191, v14, v235
    v_and_b32 v192, v15, v232
    v_and_b32 v193, v15, v233
    v_and_b32 v194, v15, v234
    v_and_b32 v195, v15, v235
L_noffn:
    s_sub_u32 s6, s2, 192
    s_lshl_b32 s7, s6, 6
    s_add_u32 s7, s7, 524288
    v_lshrrev_b32 v100, 2, v0
    v_lshlrev_b32 v100, 11, v100
    v_and_b32 v6, 3, v0
    v_lshl_add_u32 v100, v6, 4, v100
    v_add_u32 v100, s7, v100
    v_add_u32 v101, 32768, v100
    v_add_u32 v102, 65536, v100
    v_add_u32 v103, 98304, v100
    v_add_u32 v104, 131072, v100
    v_add_u32 v105, 163840, v100
    v_add_u32 v106, 196608, v100
    v_add_u32 v107, 229376, v100
    v_add_u32 v108, 262144, v100
    v_add_u32 v109, 294912, v100
    v_add_u32 v110, 327680, v100
    v_and_b32 v6, 32, v0
    v_lshlrev_b32 v6, 9, v6
    v_sub_u32 v107, v107, v6
L_tickets:
    s_lshl_b32 s7, s4, 9
    s_add_u32 s7, s7, 32768
    v_and_b32 v31, 31, v0
    v_lshlrev_b32 v28, 4, v31
    v_add_u32 v28, s7, v28
    s_lshl_b32 s11, s5, 4
    s_add_u32 s7, s7, s11
    v_mov_b32 v29, s7
    v_mov_b32 v30, 9344
    v_cmp_gt_u32 s[72:73], s5, v31
    s_mov_b32 s68, 72
    s_mov_b32 s15, 0
L_s0:
    ds_read_b128 v[24:27], v30 offset:256
    s_memrealtime s[60:61]
    s_add_u32 s15, s15, 1
    s_waitcnt lgkmcnt(0)
    v_add_u32 v24, v24, v25
    v_add3_u32 v24, v24, v26, v27
    s_nop 0
    v_readfirstlane_b32 s7, v24
    s_cmp_ge_u32 s15, 1048576
    s_cbranch_scc1 L_s0_ok
    s_cmp_ge_u32 s7, 96
    s_cbranch_scc1 L_s0_ok
    s_sleep 4
    s_branch L_s0
L_s0_ok:
    s_mov_b32 s66, s60
    s_mov_b32 s67, s7
L_s1:
    ds_read_b128 v[24:27], v30 offset:256
    s_memrealtime s[60:61]
    s_add_u32 s15, s15, 1
    s_waitcnt lgkmcnt(0)
    v_add_u32 v24, v24, v25
    v_add3_u32 v24, v24, v26, v27
    s_nop 0
    v_readfirstlane_b32 s7, v24
    s_cmp_ge_u32 s15, 1048576
    s_cbranch_scc1 L_s1_ok
    s_cmp_ge_u32 s7, 192
    s_cbranch_scc1 L_s1_ok
    s_sleep 4
    s_branch L_s1
L_s1_ok:
    s_sub_u32 s62, s60, s66
    s_sub_u32 s63, s7, s67
    s_mov_b32 s66, s60
    s_mov_b32 s67, s7
    s_min_u32 s62, s62, 0xffffff
    s_max_u32 s62, s62, 1
    s_min_u32 s63, s63, 0xffff
    s_max_u32 s63, s63, 1
    s_lshl_b32 s64, s68, 2
    s_max_u32 s64, s64, s7
    s_sub_u32 s64, s64, s7
    s_lshl_b32 s60, s60, 8
    s_lshl_b32 s64, s64, 8
    s_lshl_b32 s62, s62, 8
    s_lshl_b32 s63, s63, 8
    v_or_b32 v24, s60, v224
    v_or_b32 v25, s64, v224
    v_or_b32 v26, s62, v224
    v_or_b32 v27, s63, v224
    s_mov_b64 exec, 1
    global_store_dwordx4 v29, v[24:27], s[40:41] sc1
    s_mov_b64 exec, -1
    s_mov_b32 s15, 0
    s_sleep 100
L_pt0:
    global_load_dwordx4 v[8:11], v28, s[40:41] sc1
    s_waitcnt vmcnt(0)
    v_msad_u8 v12, v8, v224, 0
    v_msad_u8 v12, v9, v224, v12
    v_msad_u8 v12, v10, v224, v12
    v_msad_u8 v12, v11, v224, v12
    v_cmp_ne_u32 vcc, 0, v12
    s_add_u32 s15, s15, 1
    s_cmp_ge_u32 s15, 65536
    s_cbranch_scc1 L_ptd0
    s_and_b64 exec, exec, vcc
    s_cbranch_scc0 L_ptd0
    s_sleep 32
    s_branch L_pt0
L_ptd0:
    s_mov_b64 exec, -1
    v_readfirstlane_b32 s69, v8
    v_add_u32 v28, 4096, v28
    v_add_u32 v29, 4096, v29
    v_subrev_u32 v8, s69, v8
    v_ashrrev_i32 v8, 8, v8
    v_cvt_f32_i32 v8, v8
    v_lshrrev_b32 v9, 8, v9
    v_cvt_f32_u32 v9, v9
    v_lshrrev_b32 v10, 8, v10
    v_max_u32 v10, 1, v10
    v_cvt_f32_u32 v10, v10
    v_rcp_f32 v10, v10
    v_lshrrev_b32 v11, 8, v11
    v_max_u32 v11, 1, v11
    v_cvt_f32_u32 v11, v11
    v_mul_f32 v12, v10, v11
    v_mov_b32 v14, v12
    s_nop 1
    v_add_f32_dpp v14, v14, v14 quad_perm:[1,0,3,2] row_mask:0xf bank_mask:0xf
    s_nop 1
    v_add_f32_dpp v14, v14, v14 quad_perm:[2,3,0,1] row_mask:0xf bank_mask:0xf
    s_nop 1
    v_add_f32_dpp v14, v14, v14 row_half_mirror row_mask:0xf bank_mask:0xf
    s_nop 1
    v_add_f32_dpp v14, v14, v14 row_mirror row_mask:0xf bank_mask:0xf
    v_mov_b32 v16, v14
    s_nop 1
    v_permlane16_swap_b32 v14, v16
    v_add_f32 v14, v14, v16
    v_add_f32_dpp v17, v12, v12 row_ror:8 row_mask:0xf bank_mask:0xf
    v_mov_b32 v16, v17
    s_nop 1
    v_permlane16_swap_b32 v17, v16
    v_add_f32 v17, v17, v16
    v_mul_f32 v17, 0x3d800000, v17
    v_mul_f32 v13, 0x3c000000, v14
    v_add_f32 v13, v13, v17
    v_mov_b32 v15, 0x3f000000
    v_fma_f32 v12, v12, v15, v13
    v_fma_f32 v15, v8, v12, v9
    s_nop 1
    v_add_f32_dpp v15, v15, v15 quad_perm:[1,0,3,2] row_mask:0xf bank_mask:0xf
    s_nop 1
    v_add_f32_dpp v15, v15, v15 quad_perm:[2,3,0,1] row_mask:0xf bank_mask:0xf
    s_nop 1
    v_add_f32_dpp v15, v15, v15 row_half_mirror row_mask:0xf bank_mask:0xf
    s_nop 1
    v_add_f32_dpp v15, v15, v15 row_mirror row_mask:0xf bank_mask:0xf
    v_mov_b32 v16, v15
    s_nop 1
    v_permlane16_swap_b32 v15, v16
    v_add_f32 v15, v15, v16
    v_add_f32 v15, 0x45400000, v15
    v_rcp_f32 v14, v14
    s_nop 0
    v_mul_f32 v14, v14, v15
    v_sub_f32 v10, v14, v8
    v_fma_f32 v10, v10, v12, -v9
    s_mov_b32 s74, 0x41800000
    v_fma_f32 v10, s74, v10, 0.5
    v_max_f32 v10, 0, v10
    v_cvt_u32_f32 v10, v10
    v_min_u32 v10, 0xffff, v10
    v_mov_b32 v12, v10
    v_cndmask_b32 v13, 0, v10, s[72:73]
    v_subrev_f32 v14, 0x43e10000, v14
    v_cvt_i32_f32 v14, v14
    v_lshlrev_b32 v14, 8, v14
    s_nop 0
    v_readfirstlane_b32 s7, v14
    s_add_u32 s69, s69, s7
    s_and_b32 s69, s69, 0xffffff00
    v_add_u32_dpp v12, v12, v12 quad_perm:[1,0,3,2] row_mask:0xf bank_mask:0xf
    v_add_u32_dpp v13, v13, v13 quad_perm:[1,0,3,2] row_mask:0xf bank_mask:0xf
    s_nop 0
    v_add_u32_dpp v12, v12, v12 quad_perm:[2,3,0,1] row_mask:0xf bank_mask:0xf
    v_add_u32_dpp v13, v13, v13 quad_perm:[2,3,0,1] row_mask:0xf bank_mask:0xf
    s_nop 0
    v_add_u32_dpp v12, v12, v12 row_half_mirror row_mask:0xf bank_mask:0xf
    v_add_u32_dpp v13, v13, v13 row_half_mirror row_mask:0xf bank_mask:0xf
    s_nop 0
    v_add_u32_dpp v12, v12, v12 row_mirror row_mask:0xf bank_mask:0xf
    v_add_u32_dpp v13, v13, v13 row_mirror row_mask:0xf bank_mask:0xf
    v_mov_b32 v16, v12
    s_nop 1
    v_permlane16_swap_b32 v12, v16
    v_add_u32 v12, v12, v16
    v_mov_b32 v16, v13
    s_nop 1
    v_permlane16_swap_b32 v13, v16
    v_add_u32 v13, v13, v16
    v_readfirstlane_b32 s60, v12
    v_readfirstlane_b32 s61, v13
    v_readlane_b32 s62, v10, s5
    s_cmp_lg_u32 s60, 0
    s_cbranch_scc1 L_wok0
    s_mov_b32 s60, 32
    s_mov_b32 s61, s5
    s_mov_b32 s62, 1
L_wok0:
    s_add_u32 s62, s62, s61
    v_cvt_f32_u32 v12, s60
    v_rcp_f32 v12, v12
    s_nop 0
    v_mul_f32 v12, 0x44400000, v12
    v_cvt_f32_u32 v13, s61
    v_fma_f32 v13, v13, v12, 0.5
    v_cvt_u32_f32 v13, v13
    v_min_u32 v13, 768, v13
    s_cmp_eq_u32 s61, s60
    s_cselect_b32 s7, 768, 0
    v_max_u32 v13, s7, v13
    v_cvt_f32_u32 v14, s62
    v_fma_f32 v14, v14, v12, 0.5
    v_cvt_u32_f32 v14, v14
    v_min_u32 v14, 768, v14
    s_cmp_eq_u32 s62, s60
    s_cselect_b32 s7, 768, 0
    v_max_u32 v14, s7, v14
    v_readfirstlane_b32 s61, v13
    v_readfirstlane_b32 s62, v14
    s_max_u32 s62, s62, s61
    s_sub_u32 s62, s62, s61
    s_lshl_b32 s7, s5, 15
    s_sub_u32 s7, 18874368, s7
    s_lshl_b32 s64, s68, 13
    s_lshl_b32 s61, s61, 13
    s_sub_u32 s61, s61, s64
    s_add_u32 s68, s68, s62
    s_lshl_b32 s64, s68, 13
    v_mov_b32 v20, s7
    v_mov_b32 v26, 10923
    v_mov_b32 v27, 6
    v_mov_b32 v24, s64
    v_mov_b32 v25, s61
    ds_write_b128 v30, v[20:23] offset:48
    ds_write_b128 v30, v[24:27] offset:32
    s_mov_b32 s15, 0
    s_lshl_b32 s75, s68, 2
    s_sub_u32 s75, s75, 8
L_s2:
    ds_read_b128 v[24:27], v30 offset:256
    s_memrealtime s[60:61]
    s_add_u32 s15, s15, 1
    s_waitcnt lgkmcnt(0)
    v_add_u32 v24, v24, v25
    v_add3_u32 v24, v24, v26, v27
    s_nop 0
    v_readfirstlane_b32 s7, v24
    s_cmp_ge_u32 s15, 1048576
    s_cbranch_scc1 L_s2_ok
    s_lshl_b32 s62, s60, 8
    s_sub_u32 s62, s62, s69
    s_cmp_ge_i32 s62, 0
    s_cbranch_scc1 L_s2_ok
    s_cmp_ge_u32 s7, s75
    s_cbranch_scc1 L_s2_ok
    s_sleep 1
    s_branch L_s2
L_s2_ok:
    s_sub_u32 s62, s60, s66
    s_sub_u32 s63, s7, s67
    s_mov_b32 s66, s60
    s_mov_b32 s67, s7
    s_min_u32 s62, s62, 0xffffff
    s_max_u32 s62, s62, 1
    s_min_u32 s63, s63, 0xffff
    s_max_u32 s63, s63, 1
    s_lshl_b32 s64, s68, 2
    s_max_u32 s64, s64, s7
    s_sub_u32 s64, s64, s7
    s_lshl_b32 s60, s60, 8
    s_lshl_b32 s64, s64, 8
    s_lshl_b32 s62, s62, 8
    s_lshl_b32 s63, s63, 8
    v_or_b32 v24, s60, v224
    v_or_b32 v25, s64, v224
    v_or_b32 v26, s62, v224
    v_or_b32 v27, s63, v224
    s_mov_b64 exec, 1
    global_store_dwordx4 v29, v[24:27], s[40:41] sc1
    s_mov_b64 exec, -1
    s_mov_b32 s15, 0
    s_sleep 20
L_pt1:
    global_load_dwordx4 v[8:11], v28, s[40:41] sc1
    s_waitcnt vmcnt(0)
    v_msad_u8 v12, v8, v224, 0
    v_msad_u8 v12, v9, v224, v12
    v_msad_u8 v12, v10, v224, v12
    v_msad_u8 v12, v11, v224, v12
    v_cmp_ne_u32 vcc, 0, v12
    s_add_u32 s15, s15, 1
    s_cmp_ge_u32 s15, 65536
    s_cbranch_scc1 L_ptd1
    s_and_b64 exec, exec, vcc
    s_cbranch_scc0 L_ptd1
    s_sleep 8
    s_branch L_pt1
L_ptd1:
    s_mov_b64 exec, -1
    v_readfirstlane_b32 s69, v8
    v_add_u32 v28, 4096, v28
    v_add_u32 v29, 4096, v29
    v_subrev_u32 v8, s69, v8
    v_ashrrev_i32 v8, 8, v8
    v_cvt_f32_i32 v8, v8
    v_lshrrev_b32 v9, 8, v9
    v_cvt_f32_u32 v9, v9
    v_lshrrev_b32 v10, 8, v10
    v_max_u32 v10, 1, v10
    v_cvt_f32_u32 v10, v10
    v_rcp_f32 v10, v10
    v_lshrrev_b32 v11, 8, v11
    v_max_u32 v11, 1, v11
    v_cvt_f32_u32 v11, v11
    v_mul_f32 v12, v10, v11
    v_mov_b32 v14, v12
    s_nop 1
    v_add_f32_dpp v14, v14, v14 quad_perm:[1,0,3,2] row_mask:0xf bank_mask:0xf
    s_nop 1
    v_add_f32_dpp v14, v14, v14 quad_perm:[2,3,0,1] row_mask:0xf bank_mask:0xf
    s_nop 1
    v_add_f32_dpp v14, v14, v14 row_half_mirror row_mask:0xf bank_mask:0xf
    s_nop 1
    v_add_f32_dpp v14, v14, v14 row_mirror row_mask:0xf bank_mask:0xf
    v_mov_b32 v16, v14
    s_nop 1
    v_permlane16_swap_b32 v14, v16
    v_add_f32 v14, v14, v16
    v_add_f32_dpp v17, v12, v12 row_ror:8 row_mask:0xf bank_mask:0xf
    v_mov_b32 v16, v17
    s_nop 1
    v_permlane16_swap_b32 v17, v16
    v_add_f32 v17, v17, v16
    v_mul_f32 v17, 0x3d800000, v17
    v_mul_f32 v13, 0x3c000000, v14
    v_add_f32 v13, v13, v17
    v_mov_b32 v15, 0x3f000000
    v_fma_f32 v12, v12, v15, v13
    v_fma_f32 v15, v8, v12, v9
    s_nop 1
    v_add_f32_dpp v15, v15, v15 quad_perm:[1,0,3,2] row_mask:0xf bank_mask:0xf
    s_nop 1
    v_add_f32_dpp v15, v15, v15 quad_perm:[2,3,0,1] row_mask:0xf bank_mask:0xf
    s_nop 1
    v_add_f32_dpp v15, v15, v15 row_half_mirror row_mask:0xf bank_mask:0xf
    s_nop 1
    v_add_f32_dpp v15, v15, v15 row_mirror row_mask:0xf bank_mask:0xf
    v_mov_b32 v16, v15
    s_nop 1
    v_permlane16_swap_b32 v15, v16
    v_add_f32 v15, v15, v16
    v_add_f32 v15, 0x45200000, v15
    v_rcp_f32 v14, v14
    s_nop 0
    v_mul_f32 v14, v14, v15
    v_sub_f32 v10, v14, v8
    v_fma_f32 v10, v10, v12, -v9
    s_mov_b32 s74, 0x41800000
    v_fma_f32 v10, s74, v10, 0.5
    v_max_f32 v10, 0, v10
    v_cvt_u32_f32 v10, v10
    v_min_u32 v10, 0xffff, v10
    v_mov_b32 v12, v10
    v_cndmask_b32 v13, 0, v10, s[72:73]
    v_subrev_f32 v14, 0x43e10000, v14
    v_cvt_i32_f32 v14, v14
    v_lshlrev_b32 v14, 8, v14
    s_nop 0
    v_readfirstlane_b32 s7, v14
    s_add_u32 s69, s69, s7
    s_and_b32 s69, s69, 0xffffff00
    v_add_u32_dpp v12, v12, v12 quad_perm:[1,0,3,2] row_mask:0xf bank_mask:0xf
    v_add_u32_dpp v13, v13, v13 quad_perm:[1,0,3,2] row_mask:0xf bank_mask:0xf
    s_nop 0
    v_add_u32_dpp v12, v12, v12 quad_perm:[2,3,0,1] row_mask:0xf bank_mask:0xf
    v_add_u32_dpp v13, v13, v13 quad_perm:[2,3,0,1] row_mask:0xf bank_mask:0xf
    s_nop 0
    v_add_u32_dpp v12, v12, v12 row_half_mirror row_mask:0xf bank_mask:0xf
    v_add_u32_dpp v13, v13, v13 row_half_mirror row_mask:0xf bank_mask:0xf
    s_nop 0
    v_add_u32_dpp v12, v12, v12 row_mirror row_mask:0xf bank_mask:0xf
    v_add_u32_dpp v13, v13, v13 row_mirror row_mask:0xf bank_mask:0xf
    v_mov_b32 v16, v12
    s_nop 1
    v_permlane16_swap_b32 v12, v16
    v_add_u32 v12, v12, v16
    v_mov_b32 v16, v13
    s_nop 1
    v_permlane16_swap_b32 v13, v16
    v_add_u32 v13, v13, v16
    v_readfirstlane_b32 s60, v12
    v_readfirstlane_b32 s61, v13
    v_readlane_b32 s62, v10, s5
    s_cmp_lg_u32 s60, 0
    s_cbranch_scc1 L_wok1
    s_mov_b32 s60, 32
    s_mov_b32 s61, s5
    s_mov_b32 s62, 1
L_wok1:
    s_add_u32 s62, s62, s61
    v_cvt_f32_u32 v12, s60
    v_rcp_f32 v12, v12
    s_nop 0
    v_mul_f32 v12, 0x44200000, v12
    v_cvt_f32_u32 v13, s61
    v_fma_f32 v13, v13, v12, 0.5
    v_cvt_u32_f32 v13, v13
    v_min_u32 v13, 640, v13
    s_cmp_eq_u32 s61, s60
    s_cselect_b32 s7, 640, 0
    v_max_u32 v13, s7, v13
    v_cvt_f32_u32 v14, s62
    v_fma_f32 v14, v14, v12, 0.5
    v_cvt_u32_f32 v14, v14
    v_min_u32 v14, 640, v14
    s_cmp_eq_u32 s62, s60
    s_cselect_b32 s7, 640, 0
    v_max_u32 v14, s7, v14
    v_readfirstlane_b32 s61, v13
    v_readfirstlane_b32 s62, v14
    s_max_u32 s62, s62, s61
    s_sub_u32 s62, s62, s61
    s_lshl_b32 s7, s5, 15
    s_sub_u32 s7, 25165824, s7
    s_lshl_b32 s64, s68, 13
    s_lshl_b32 s61, s61, 13
    s_sub_u32 s61, s61, s64
    s_add_u32 s68, s68, s62
    s_lshl_b32 s64, s68, 13
    v_mov_b32 v20, s7
    v_mov_b32 v26, 13108
    v_mov_b32 v27, 5
    v_mov_b32 v24, s64
    v_mov_b32 v25, s61
    ds_write_b128 v30, v[20:23] offset:80
    ds_write_b128 v30, v[24:27] offset:64
    s_mov_b32 s15, 0
    s_lshl_b32 s75, s68, 2
    s_sub_u32 s75, s75, 8
L_s3:
    ds_read_b128 v[24:27], v30 offset:256
    s_memrealtime s[60:61]
    s_add_u32 s15, s15, 1
    s_waitcnt lgkmcnt(0)
    v_add_u32 v24, v24, v25
    v_add3_u32 v24, v24, v26, v27
    s_nop 0
    v_readfirstlane_b32 s7, v24
    s_cmp_ge_u32 s15, 1048576
    s_cbranch_scc1 L_s3_ok
    s_lshl_b32 s62, s60, 8
    s_sub_u32 s62, s62, s69
    s_cmp_ge_i32 s62, 0
    s_cbranch_scc1 L_s3_ok
    s_cmp_ge_u32 s7, s75
    s_cbranch_scc1 L_s3_ok
    s_sleep 1
    s_branch L_s3
L_s3_ok:
    s_sub_u32 s62, s60, s66
    s_sub_u32 s63, s7, s67
    s_mov_b32 s66, s60
    s_mov_b32 s67, s7
    s_min_u32 s62, s62, 0xffffff
    s_max_u32 s62, s62, 1
    s_min_u32 s63, s63, 0xffff
    s_max_u32 s63, s63, 1
    s_lshl_b32 s64, s68, 2
    s_max_u32 s64, s64, s7
    s_sub_u32 s64, s64, s7
    s_lshl_b32 s60, s60, 8
    s_lshl_b32 s64, s64, 8
    s_lshl_b32 s62, s62, 8
    s_lshl_b32 s63, s63, 8
    v_or_b32 v24, s60, v224
    v_or_b32 v25, s64, v224
    v_or_b32 v26, s62, v224
    v_or_b32 v27, s63, v224
    s_mov_b64 exec, 1
    global_store_dwordx4 v29, v[24:27], s[40:41] sc1
    s_mov_b64 exec, -1
    s_mov_b32 s15, 0
    s_sleep 20
L_pt2:
    global_load_dwordx4 v[8:11], v28, s[40:41] sc1
    s_waitcnt vmcnt(0)
    v_msad_u8 v12, v8, v224, 0
    v_msad_u8 v12, v9, v224, v12
    v_msad_u8 v12, v10, v224, v12
    v_msad_u8 v12, v11, v224, v12
    v_cmp_ne_u32 vcc, 0, v12
    s_add_u32 s15, s15, 1
    s_cmp_ge_u32 s15, 65536
    s_cbranch_scc1 L_ptd2
    s_and_b64 exec, exec, vcc
    s_cbranch_scc0 L_ptd2
    s_sleep 8
    s_branch L_pt2
L_ptd2:
    s_mov_b64 exec, -1
    v_readfirstlane_b32 s69, v8
    v_add_u32 v28, 4096, v28
    v_add_u32 v29, 4096, v29
    v_subrev_u32 v8, s69, v8
    v_ashrrev_i32 v8, 8, v8
    v_cvt_f32_i32 v8, v8
    v_lshrrev_b32 v9, 8, v9
    v_cvt_f32_u32 v9, v9
    v_lshrrev_b32 v10, 8, v10
    v_max_u32 v10, 1, v10
    v_cvt_f32_u32 v10, v10
    v_rcp_f32 v10, v10
    v_lshrrev_b32 v11, 8, v11
    v_max_u32 v11, 1, v11
    v_cvt_f32_u32 v11, v11
    v_mul_f32 v12, v10, v11
    v_mov_b32 v14, v12
    s_nop 1
    v_add_f32_dpp v14, v14, v14 quad_perm:[1,0,3,2] row_mask:0xf bank_mask:0xf
    s_nop 1
    v_add_f32_dpp v14, v14, v14 quad_perm:[2,3,0,1] row_mask:0xf bank_mask:0xf
    s_nop 1
    v_add_f32_dpp v14, v14, v14 row_half_mirror row_mask:0xf bank_mask:0xf
    s_nop 1
    v_add_f32_dpp v14, v14, v14 row_mirror row_mask:0xf bank_mask:0xf
    v_mov_b32 v16, v14
    s_nop 1
    v_permlane16_swap_b32 v14, v16
    v_add_f32 v14, v14, v16
    v_add_f32_dpp v17, v12, v12 row_ror:8 row_mask:0xf bank_mask:0xf
    v_mov_b32 v16, v17
    s_nop 1
    v_permlane16_swap_b32 v17, v16
    v_add_f32 v17, v17, v16
    v_mul_f32 v17, 0x3dcccccd, v17
    v_mul_f32 v13, 0x3c4ccccd, v14
    v_add_f32 v13, v13, v17
    v_mov_b32 v15, 0x3e4ccccd
    v_fma_f32 v12, v12, v15, v13
    v_fma_f32 v15, v8, v12, v9
    s_nop 1
    v_add_f32_dpp v15, v15, v15 quad_perm:[1,0,3,2] row_mask:0xf bank_mask:0xf
    s_nop 1
    v_add_f32_dpp v15, v15, v15 quad_perm:[2,3,0,1] row_mask:0xf bank_mask:0xf
    s_nop 1
    v_add_f32_dpp v15, v15, v15 row_half_mirror row_mask:0xf bank_mask:0xf
    s_nop 1
    v_add_f32_dpp v15, v15, v15 row_mirror row_mask:0xf bank_mask:0xf
    v_mov_b32 v16, v15
    s_nop 1
    v_permlane16_swap_b32 v15, v16
    v_add_f32 v15, v15, v16
    v_add_f32 v15, 0x44800000, v15
    v_rcp_f32 v14, v14
    s_nop 0
    v_mul_f32 v14, v14, v15
    v_sub_f32 v10, v14, v8
    v_fma_f32 v10, v10, v12, -v9
    s_mov_b32 s74, 0x41800000
    v_fma_f32 v10, s74, v10, 0.5
    v_max_f32 v10, 0, v10
    v_cvt_u32_f32 v10, v10
    v_min_u32 v10, 0xffff, v10
    v_mov_b32 v12, v10
    v_cndmask_b32 v13, 0, v10, s[72:73]
    v_subrev_f32 v14, 0x43be0000, v14
    v_cvt_i32_f32 v14, v14
    v_lshlrev_b32 v14, 8, v14
    s_nop 0
    v_readfirstlane_b32 s7, v14
    s_add_u32 s69, s69, s7
    s_and_b32 s69, s69, 0xffffff00
    v_add_u32_dpp v12, v12, v12 quad_perm:[1,0,3,2] row_mask:0xf bank_mask:0xf
    v_add_u32_dpp v13, v13, v13 quad_perm:[1,0,3,2] row_mask:0xf bank_mask:0xf
    s_nop 0
    v_add_u32_dpp v12, v12, v12 quad_perm:[2,3,0,1] row_mask:0xf bank_mask:0xf
    v_add_u32_dpp v13, v13, v13 quad_perm:[2,3,0,1] row_mask:0xf bank_mask:0xf
    s_nop 0
    v_add_u32_dpp v12, v12, v12 row_half_mirror row_mask:0xf bank_mask:0xf
    v_add_u32_dpp v13, v13, v13 row_half_mirror row_mask:0xf bank_mask:0xf
    s_nop 0
    v_add_u32_dpp v12, v12, v12 row_mirror row_mask:0xf bank_mask:0xf
    v_add_u32_dpp v13, v13, v13 row_mirror row_mask:0xf bank_mask:0xf
    v_mov_b32 v16, v12
    s_nop 1
    v_permlane16_swap_b32 v12, v16
    v_add_u32 v12, v12, v16
    v_mov_b32 v16, v13
    s_nop 1
    v_permlane16_swap_b32 v13, v16
    v_add_u32 v13, v13, v16
    v_readfirstlane_b32 s60, v12
    v_readfirstlane_b32 s61, v13
    v_readlane_b32 s62, v10, s5
    s_cmp_lg_u32 s60, 0
    s_cbranch_scc1 L_wok2
    s_mov_b32 s60, 32
    s_mov_b32 s61, s5
    s_mov_b32 s62, 1
L_wok2:
    s_add_u32 s62, s62, s61
    v_cvt_f32_u32 v12, s60
    v_rcp_f32 v12, v12
    s_nop 0
    v_mul_f32 v12, 0x43800000, v12
    v_cvt_f32_u32 v13, s61
    v_fma_f32 v13, v13, v12, 0.5
    v_cvt_u32_f32 v13, v13
    v_min_u32 v13, 256, v13
    s_cmp_eq_u32 s61, s60
    s_cselect_b32 s7, 256, 0
    v_max_u32 v13, s7, v13
    v_cvt_f32_u32 v14, s62
    v_fma_f32 v14, v14, v12, 0.5
    v_cvt_u32_f32 v14, v14
    v_min_u32 v14, 256, v14
    s_cmp_eq_u32 s62, s60
    s_cselect_b32 s7, 256, 0
    v_max_u32 v14, s7, v14
    v_readfirstlane_b32 s61, v13
    v_readfirstlane_b32 s62, v14
    s_max_u32 s62, s62, s61
    s_sub_u32 s62, s62, s61
    s_lshl_b32 s7, s5, 15
    s_sub_u32 s7, 30408704, s7
    s_lshl_b32 s64, s68, 13
    s_lshl_b32 s61, s61, 13
    s_sub_u32 s61, s61, s64
    s_add_u32 s68, s68, s62
    s_lshl_b32 s64, s68, 13
    v_mov_b32 v20, s7
    v_mov_b32 v26, 32768
    v_mov_b32 v27, 2
    v_mov_b32 v24, s64
    v_mov_b32 v25, s61
    ds_write_b128 v30, v[20:23] offset:112
    ds_write_b128 v30, v[24:27] offset:96
    s_mov_b32 s15, 0
    s_lshl_b32 s75, s68, 2
    s_sub_u32 s75, s75, 8
L_s4:
    ds_read_b128 v[24:27], v30 offset:256
    s_memrealtime s[60:61]
    s_add_u32 s15, s15, 1
    s_waitcnt lgkmcnt(0)
    v_add_u32 v24, v24, v25
    v_add3_u32 v24, v24, v26, v27
    s_nop 0
    v_readfirstlane_b32 s7, v24
    s_cmp_ge_u32 s15, 1048576
    s_cbranch_scc1 L_s4_ok
    s_lshl_b32 s62, s60, 8
    s_sub_u32 s62, s62, s69
    s_cmp_ge_i32 s62, 0
    s_cbranch_scc1 L_s4_ok
    s_cmp_ge_u32 s7, s75
    s_cbranch_scc1 L_s4_ok
    s_sleep 1
    s_branch L_s4
L_s4_ok:
    s_sub_u32 s62, s60, s66
    s_sub_u32 s63, s7, s67
    s_mov_b32 s66, s60
    s_mov_b32 s67, s7
    s_min_u32 s62, s62, 0xffffff
    s_max_u32 s62, s62, 1
    s_min_u32 s63, s63, 0xffff
    s_max_u32 s63, s63, 1
    s_lshl_b32 s64, s68, 2
    s_max_u32 s64, s64, s7
    s_sub_u32 s64, s64, s7
    s_lshl_b32 s60, s60, 8
    s_lshl_b32 s64, s64, 8
    s_lshl_b32 s62, s62, 8
    s_lshl_b32 s63, s63, 8
    v_or_b32 v24, s60, v224
    v_or_b32 v25, s64, v224
    v_or_b32 v26, s62, v224
    v_or_b32 v27, s63, v224
    s_mov_b64 exec, 1
    global_store_dwordx4 v29, v[24:27], s[40:41] sc1
    s_mov_b64 exec, -1
    s_mov_b32 s15, 0
    s_sleep 20
L_pt3:
    global_load_dwordx4 v[8:11], v28, s[40:41] sc1
    s_waitcnt vmcnt(0)
    v_msad_u8 v12, v8, v224, 0
    v_msad_u8 v12, v9, v224, v12
    v_msad_u8 v12, v10, v224, v12
    v_msad_u8 v12, v11, v224, v12
    v_cmp_ne_u32 vcc, 0, v12
    s_add_u32 s15, s15, 1
    s_cmp_ge_u32 s15, 65536
    s_cbranch_scc1 L_ptd3
    s_and_b64 exec, exec, vcc
    s_cbranch_scc0 L_ptd3
    s_sleep 8
    s_branch L_pt3
L_ptd3:
    s_mov_b64 exec, -1
    v_readfirstlane_b32 s69, v8
    v_add_u32 v28, 4096, v28
    v_add_u32 v29, 4096, v29
    v_subrev_u32 v8, s69, v8
    v_ashrrev_i32 v8, 8, v8
    v_cvt_f32_i32 v8, v8
    v_lshrrev_b32 v9, 8, v9
    v_cvt_f32_u32 v9, v9
    v_lshrrev_b32 v10, 8, v10
    v_max_u32 v10, 1, v10
    v_cvt_f32_u32 v10, v10
    v_rcp_f32 v10, v10
    v_lshrrev_b32 v11, 8, v11
    v_max_u32 v11, 1, v11
    v_cvt_f32_u32 v11, v11
    v_mul_f32 v12, v10, v11
    v_mov_b32 v14, v12
    s_nop 1
    v_add_f32_dpp v14, v14, v14 quad_perm:[1,0,3,2] row_mask:0xf bank_mask:0xf
    s_nop 1
    v_add_f32_dpp v14, v14, v14 quad_perm:[2,3,0,1] row_mask:0xf bank_mask:0xf
    s_nop 1
    v_add_f32_dpp v14, v14, v14 row_half_mirror row_mask:0xf bank_mask:0xf
    s_nop 1
    v_add_f32_dpp v14, v14, v14 row_mirror row_mask:0xf bank_mask:0xf
    v_mov_b32 v16, v14
    s_nop 1
    v_permlane16_swap_b32 v14, v16
    v_add_f32 v14, v14, v16
    v_add_f32_dpp v17, v12, v12 row_ror:8 row_mask:0xf bank_mask:0xf
    v_mov_b32 v16, v17
    s_nop 1
    v_permlane16_swap_b32 v17, v16
    v_add_f32 v17, v17, v16
    v_mul_f32 v17, 0x3e000000, v17
    v_mul_f32 v13, 0x3c800000, v14
    v_add_f32 v13, v13, v17
    v_mov_b32 v15, 0x00000000
    v_fma_f32 v12, v12, v15, v13
    v_fma_f32 v15, v8, v12, v9
    s_nop 1
    v_add_f32_dpp v15, v15, v15 quad_perm:[1,0,3,2] row_mask:0xf bank_mask:0xf
    s_nop 1
    v_add_f32_dpp v15, v15, v15 quad_perm:[2,3,0,1] row_mask:0xf bank_mask:0xf
    s_nop 1
    v_add_f32_dpp v15, v15, v15 row_half_mirror row_mask:0xf bank_mask:0xf
    s_nop 1
    v_add_f32_dpp v15, v15, v15 row_mirror row_mask:0xf bank_mask:0xf
    v_mov_b32 v16, v15
    s_nop 1
    v_permlane16_swap_b32 v15, v16
    v_add_f32 v15, v15, v16
    v_add_f32 v15, 0x44000000, v15
    v_rcp_f32 v14, v14
    s_nop 0
    v_mul_f32 v14, v14, v15
    v_sub_f32 v10, v14, v8
    v_fma_f32 v10, v10, v12, -v9
    s_mov_b32 s74, 0x41800000
    v_fma_f32 v10, s74, v10, 0.5
    v_max_f32 v10, 0, v10
    v_cvt_u32_f32 v10, v10
    v_min_u32 v10, 0xffff, v10
    v_mov_b32 v12, v10
    v_cndmask_b32 v13, 0, v10, s[72:73]
    s_nop 0
    v_add_u32_dpp v12, v12, v12 quad_perm:[1,0,3,2] row_mask:0xf bank_mask:0xf
    v_add_u32_dpp v13, v13, v13 quad_perm:[1,0,3,2] row_mask:0xf bank_mask:0xf
    s_nop 0
    v_add_u32_dpp v12, v12, v12 quad_perm:[2,3,0,1] row_mask:0xf bank_mask:0xf
    v_add_u32_dpp v13, v13, v13 quad_perm:[2,3,0,1] row_mask:0xf bank_mask:0xf
    s_nop 0
    v_add_u32_dpp v12, v12, v12 row_half_mirror row_mask:0xf bank_mask:0xf
    v_add_u32_dpp v13, v13, v13 row_half_mirror row_mask:0xf bank_mask:0xf
    s_nop 0
    v_add_u32_dpp v12, v12, v12 row_mirror row_mask:0xf bank_mask:0xf
    v_add_u32_dpp v13, v13, v13 row_mirror row_mask:0xf bank_mask:0xf
    v_mov_b32 v16, v12
    s_nop 1
    v_permlane16_swap_b32 v12, v16
    v_add_u32 v12, v12, v16
    v_mov_b32 v16, v13
    s_nop 1
    v_permlane16_swap_b32 v13, v16
    v_add_u32 v13, v13, v16
    v_readfirstlane_b32 s60, v12
    v_readfirstlane_b32 s61, v13
    v_readlane_b32 s62, v10, s5
    s_cmp_lg_u32 s60, 0
    s_cbranch_scc1 L_wok3
    s_mov_b32 s60, 32
    s_mov_b32 s61, s5
    s_mov_b32 s62, 1
L_wok3:
    s_add_u32 s62, s62, s61
    v_cvt_f32_u32 v12, s60
    v_rcp_f32 v12, v12
    s_nop 0
    v_mul_f32 v12, 0x44000000, v12
    v_cvt_f32_u32 v13, s61
    v_fma_f32 v13, v13, v12, 0.5
    v_cvt_u32_f32 v13, v13
    v_min_u32 v13, 512, v13
    s_cmp_eq_u32 s61, s60
    s_cselect_b32 s7, 512, 0
    v_max_u32 v13, s7, v13
    v_cvt_f32_u32 v14, s62
    v_fma_f32 v14, v14, v12, 0.5
    v_cvt_u32_f32 v14, v14
    v_min_u32 v14, 512, v14
    s_cmp_eq_u32 s62, s60
    s_cselect_b32 s7, 512, 0
    v_max_u32 v14, s7, v14
    v_readfirstlane_b32 s61, v13
    v_readfirstlane_b32 s62, v14
    s_max_u32 s62, s62, s61
    s_sub_u32 s62, s62, s61
    s_lshl_b32 s7, s5, 15
    s_sub_u32 s7, 32505856, s7
    s_lshl_b32 s64, s68, 13
    s_max_u32 s63, s62, 8
    s_sub_u32 s63, s63, 8
    s_lshr_b32 s63, s63, 2
    s_lshl_b32 s65, s63, 2
    s_sub_u32 s62, s62, s65
    s_add_u32 s75, s68, s63
    s_lshl_b32 s75, s75, 2
    s_add_u32 s75, s75, s62
    s_sub_u32 s75, s75, 8
    s_lshl_b32 s62, s62, 11
    s_add_u32 s65, s65, s61
    s_lshl_b32 s65, s65, 11
    s_lshl_b32 s61, s61, 11
    s_sub_u32 s61, s61, s64
    s_add_u32 s68, s68, s63
    s_lshl_b32 s64, s68, 13
    v_mov_b32 v20, s7
    v_mov_b32 v21, s62
    v_mov_b32 v22, s65
    v_mov_b32 v26, 0x10000
    v_mov_b32 v27, 1
    v_mov_b32 v24, s64
    v_mov_b32 v25, s61
    ds_write_b128 v30, v[20:23] offset:144
    ds_write_b128 v30, v[24:27] offset:128
    s_mov_b32 s15, 0
L_sw:
    ds_read_b128 v[24:27], v30 offset:256
    s_memrealtime s[60:61]
    s_add_u32 s15, s15, 1
    s_waitcnt lgkmcnt(0)
    v_add_u32 v24, v24, v25
    v_add3_u32 v24, v24, v26, v27
    s_nop 0
    v_readfirstlane_b32 s7, v24
    s_cmp_ge_u32 s15, 1048576
    s_cbranch_scc1 L_sw_ok
    s_cmp_ge_u32 s7, s75
    s_cbranch_scc1 L_sw_ok
    s_sleep 1
    s_branch L_sw
L_sw_ok:
    v_mov_b32 v227, 1
    s_mov_b64 exec, 1
    global_atomic_add v228, v226, v227, s[40:41] sc0
    s_mov_b64 exec, -1
    s_waitcnt vmcnt(0)
    s_mov_b64 exec, 1
    v_add_u32 v228, 1, v228
    ds_write_b32 v30, v228 offset:12
    s_mov_b64 exec, -1
    s_add_u32 s75, s75, 8
    s_mov_b32 s15, 0
    s_cmp_ge_u32 s9, 7
    s_cbranch_scc1 L_nf2
L_sw2:
    ds_read_b128 v[24:27], v30 offset:256
    s_memrealtime s[60:61]
    s_add_u32 s15, s15, 1
    s_waitcnt lgkmcnt(0)
    v_add_u32 v24, v24, v25
    v_add3_u32 v24, v24, v26, v27
    s_nop 0
    v_readfirstlane_b32 s7, v24
    s_cmp_ge_u32 s15, 1048576
    s_cbranch_scc1 L_sw2_ok
    s_cmp_ge_u32 s7, s75
    s_cbranch_scc1 L_sw2_ok
    s_sleep 1
    s_branch L_sw2
L_sw2_ok:
    buffer_load_dwordx4 v[36:39], v1, s[52:55], 0 offen offset:0 nt
    buffer_load_dwordx4 v[40:43], v1, s[52:55], 0 offen offset:256 nt
    buffer_load_dwordx4 v[44:47], v1, s[52:55], 0 offen offset:512 nt
    buffer_load_dwordx4 v[48:51], v1, s[52:55], 0 offen offset:768 nt
    buffer_load_dwordx4 v[52:55], v1, s[52:55], 0 offen offset:896 nt
    buffer_load_dwordx4 v[56:59], v1, s[52:55], 0 offen offset:1152 nt
    buffer_load_dwordx4 v[60:63], v1, s[52:55], 0 offen offset:1408 nt
    buffer_load_dwordx4 v[64:67], v1, s[52:55], 0 offen offset:1664 nt
    s_mov_b32 s56, 7168
    buffer_load_dwordx4 v[68:71], v1, s[52:55], s56 offen offset:0 nt
    buffer_load_dwordx4 v[72:75], v1, s[52:55], s56 offen offset:256 nt
    buffer_load_dwordx4 v[76:79], v1, s[52:55], s56 offen offset:512 nt
    buffer_load_dwordx4 v[80:83], v1, s[52:55], s56 offen offset:768 nt
    buffer_load_dwordx4 v[84:87], v1, s[52:55], s56 offen offset:896 nt
    buffer_load_dwordx4 v[88:91], v1, s[52:55], s56 offen offset:1152 nt
    buffer_load_dwordx4 v[92:95], v1, s[52:55], s56 offen offset:1408 nt
    buffer_load_dwordx4 v[96:99], v1, s[52:55], s56 offen offset:1664 nt
    s_mov_b32 s56, 14336
    buffer_load_dwordx4 v[100:103], v1, s[52:55], s56 offen offset:0 nt
    buffer_load_dwordx4 v[104:107], v1, s[52:55], s56 offen offset:256 nt
    buffer_load_dwordx4 v[108:111], v1, s[52:55], s56 offen offset:512 nt
    buffer_load_dwordx4 v[112:115], v1, s[52:55], s56 offen offset:768 nt
    buffer_load_dwordx4 v[116:119], v1, s[52:55], s56 offen offset:896 nt
    buffer_load_dwordx4 v[120:123], v1, s[52:55], s56 offen offset:1152 nt
    buffer_load_dwordx4 v[124:127], v1, s[52:55], s56 offen offset:1408 nt
    buffer_load_dwordx4 v[128:131], v1, s[52:55], s56 offen offset:1664 nt
    s_mov_b32 s56, 21504
    buffer_load_dwordx4 v[132:135], v1, s[52:55], s56 offen offset:0 nt
    buffer_load_dwordx4 v[136:139], v1, s[52:55], s56 offen offset:256 nt
    buffer_load_dwordx4 v[140:143], v1, s[52:55], s56 offen offset:512 nt
    buffer_load_dwordx4 v[144:147], v1, s[52:55], s56 offen offset:768 nt
    buffer_load_dwordx4 v[148:151], v1, s[52:55], s56 offen offset:896 nt
    buffer_load_dwordx4 v[152:155], v1, s[52:55], s56 offen offset:1152 nt
    buffer_load_dwordx4 v[156:159], v1, s[52:55], s56 offen offset:1408 nt
    buffer_load_dwordx4 v[160:163], v1, s[52:55], s56 offen offset:1664 nt
    s_barrier
    s_waitcnt vmcnt(28)
    v_mfma_f32_16x16x32_bf16 v[196:199], v[164:167], v[36:39], 0
    v_mfma_f32_16x16x32_bf16 v[200:203], v[164:167], v[40:43], 0
    v_mfma_f32_16x16x32_bf16 v[204:207], v[164:167], v[44:47], 0
    v_mfma_f32_16x16x32_bf16 v[208:211], v[164:167], v[48:51], 0
    s_waitcnt vmcnt(24)
    v_mfma_f32_16x16x32_bf16 v[196:199], v[168:171], v[52:55], v[196:199]
    v_mfma_f32_16x16x32_bf16 v[200:203], v[168:171], v[56:59], v[200:203]
    v_mfma_f32_16x16x32_bf16 v[204:207], v[168:171], v[60:63], v[204:207]
    v_mfma_f32_16x16x32_bf16 v[208:211], v[168:171], v[64:67], v[208:211]
    s_waitcnt vmcnt(20)
    v_mfma_f32_16x16x32_bf16 v[196:199], v[172:175], v[68:71], v[196:199]
    v_mfma_f32_16x16x32_bf16 v[200:203], v[172:175], v[72:75], v[200:203]
    v_mfma_f32_16x16x32_bf16 v[204:207], v[172:175], v[76:79], v[204:207]
    v_mfma_f32_16x16x32_bf16 v[208:211], v[172:175], v[80:83], v[208:211]
    s_waitcnt vmcnt(16)
    v_mfma_f32_16x16x32_bf16 v[196:199], v[176:179], v[84:87], v[196:199]
    v_mfma_f32_16x16x32_bf16 v[200:203], v[176:179], v[88:91], v[200:203]
    v_mfma_f32_16x16x32_bf16 v[204:207], v[176:179], v[92:95], v[204:207]
    v_mfma_f32_16x16x32_bf16 v[208:211], v[176:179], v[96:99], v[208:211]
    s_waitcnt vmcnt(12)
    v_mfma_f32_16x16x32_bf16 v[196:199], v[180:183], v[100:103], v[196:199]
    v_mfma_f32_16x16x32_bf16 v[200:203], v[180:183], v[104:107], v[200:203]
    v_mfma_f32_16x16x32_bf16 v[204:207], v[180:183], v[108:111], v[204:207]
    v_mfma_f32_16x16x32_bf16 v[208:211], v[180:183], v[112:115], v[208:211]
    s_waitcnt vmcnt(8)
    v_mfma_f32_16x16x32_bf16 v[196:199], v[184:187], v[116:119], v[196:199]
    v_mfma_f32_16x16x32_bf16 v[200:203], v[184:187], v[120:123], v[200:203]
    v_mfma_f32_16x16x32_bf16 v[204:207], v[184:187], v[124:127], v[204:207]
    v_mfma_f32_16x16x32_bf16 v[208:211], v[184:187], v[128:131], v[208:211]
    s_waitcnt vmcnt(4)
    v_mfma_f32_16x16x32_bf16 v[196:199], v[188:191], v[132:135], v[196:199]
    v_mfma_f32_16x16x32_bf16 v[200:203], v[188:191], v[136:139], v[200:203]
    v_mfma_f32_16x16x32_bf16 v[204:207], v[188:191], v[140:143], v[204:207]
    v_mfma_f32_16x16x32_bf16 v[208:211], v[188:191], v[144:147], v[208:211]
    s_waitcnt vmcnt(0)
    v_mfma_f32_16x16x32_bf16 v[196:199], v[192:195], v[148:151], v[196:199]
    v_mfma_f32_16x16x32_bf16 v[200:203], v[192:195], v[152:155], v[200:203]
    v_mfma_f32_16x16x32_bf16 v[204:207], v[192:195], v[156:159], v[204:207]
    v_mfma_f32_16x16x32_bf16 v[208:211], v[192:195], v[160:163], v[208:211]
    s_nop 4
    v_mul_f32 v196, v230, v196
    v_mul_f32 v197, v230, v197
    v_mul_f32 v198, v230, v198
    v_mul_f32 v199, v230, v199
    v_mul_f32 v200, v230, v200
    v_mul_f32 v201, v230, v201
    v_mul_f32 v202, v230, v202
    v_mul_f32 v203, v230, v203
    v_mul_f32 v204, v230, v204
    v_mul_f32 v205, v230, v205
    v_mul_f32 v206, v230, v206
    v_mul_f32 v207, v230, v207
    v_mul_f32 v208, v230, v208
    v_mul_f32 v209, v230, v209
    v_mul_f32 v210, v230, v210
    v_mul_f32 v211, v230, v211
    v_and_or_b32 v196, v196, s57, v224
    v_and_or_b32 v197, v197, s57, v224
    v_and_or_b32 v198, v198, s57, v224
    v_and_or_b32 v199, v199, s57, v224
    v_and_or_b32 v200, v200, s57, v224
    v_and_or_b32 v201, v201, s57, v224
    v_and_or_b32 v202, v202, s57, v224
    v_and_or_b32 v203, v203, s57, v224
    v_and_or_b32 v204, v204, s57, v224
    v_and_or_b32 v205, v205, s57, v224
    v_and_or_b32 v206, v206, s57, v224
    v_and_or_b32 v207, v207, s57, v224
    v_and_or_b32 v208, v208, s57, v224
    v_and_or_b32 v209, v209, s57, v224
    v_and_or_b32 v210, v210, s57, v224
    v_and_or_b32 v211, v211, s57, v224
    s_mov_b32 exec_hi, 0
    global_store_dwordx4 v2, v[196:199], s[40:41] offset:0 sc1
    global_store_dwordx4 v2, v[200:203], s[40:41] offset:512 sc1
    global_store_dwordx4 v2, v[204:207], s[40:41] offset:1024 sc1
    s_mov_b32 exec_lo, 0x00ff00ff
    global_store_dwordx4 v2, v[208:211], s[40:41] offset:1536 sc1
    s_mov_b64 exec, -1
    s_endpgm
L_nf2:
    s_lshl_b32 s7, s6, 5
    v_and_b32 v1, 3, v0
    v_lshlrev_b32 v1, 3, v1
    v_lshl_add_u32 v1, v5, 1, v1
    v_add_u32 v1, s7, v1
    v_mov_b32 v6, 28672
    s_barrier
    s_waitcnt vmcnt(0)
    s_mov_b64 exec, 1
    s_mov_b64 exec, -1
    s_cmp_ge_u32 s6, 28
    s_cbranch_scc1 L_end
    s_mov_b32 s15, 0
L_pollF:
    global_load_dwordx4 v[32:35], v104, s[40:41] sc1
    global_load_dwordx4 v[36:39], v105, s[40:41] sc1
    global_load_dwordx4 v[40:43], v106, s[40:41] sc1
    global_load_dwordx4 v[44:47], v107, s[40:41] sc1
    s_waitcnt vmcnt(0)
    v_msad_u8 v24, v32, v224, 0
    v_msad_u8 v25, v33, v224, 0
    v_msad_u8 v26, v34, v224, 0
    v_msad_u8 v27, v35, v224, 0
    v_msad_u8 v24, v36, v224, v24
    v_msad_u8 v25, v37, v224, v25
    v_msad_u8 v26, v38, v224, v26
    v_msad_u8 v27, v39, v224, v27
    v_msad_u8 v24, v40, v224, v24
    v_msad_u8 v25, v41, v224, v25
    v_msad_u8 v26, v42, v224, v26
    v_msad_u8 v27, v43, v224, v27
    v_msad_u8 v24, v44, v224, v24
    v_msad_u8 v25, v45, v224, v25
    v_msad_u8 v26, v46, v224, v26
    v_msad_u8 v27, v47, v224, v27
    v_or3_b32 v24, v24, v25, v26
    v_or_b32 v24, v24, v27
    v_cmp_ne_u32 vcc, 0, v24
    s_add_u32 s15, s15, 1
    s_cmp_ge_u32 s15, 65536
    s_cbranch_scc1 L_pollF_done
    s_and_b64 exec, exec, vcc
    s_cbranch_scc0 L_pollF_done
    s_branch L_pollF
L_pollF_done:
    s_mov_b64 exec, -1
    s_mov_b32 s15, 0
    global_load_dwordx4 v[64:67], v100, s[40:41] sc1
    global_load_dwordx4 v[68:71], v101, s[40:41] sc1
    global_load_dwordx4 v[72:75], v102, s[40:41] sc1
    global_load_dwordx4 v[76:79], v103, s[40:41] sc1
    s_mov_b32 exec_lo, 0
    v_mov_b32 v44, 0
    v_mov_b32 v45, 0
    v_mov_b32 v46, 0
    v_mov_b32 v47, 0
    s_mov_b32 exec_lo, -1
    v_pk_add_f32 v[32:33], v[32:33], v[36:37]
    v_pk_add_f32 v[34:35], v[34:35], v[38:39]
    v_pk_add_f32 v[40:41], v[40:41], v[44:45]
    v_pk_add_f32 v[42:43], v[42:43], v[46:47]
    v_pk_add_f32 v[32:33], v[32:33], v[40:41]
    v_pk_add_f32 v[34:35], v[34:35], v[42:43]
    s_sleep 8
L_pollA:
    global_load_dwordx4 v[64:67], v100, s[40:41] sc1
    global_load_dwordx4 v[68:71], v101, s[40:41] sc1
    global_load_dwordx4 v[72:75], v102, s[40:41] sc1
    global_load_dwordx4 v[76:79], v103, s[40:41] sc1
L_pollA1:
    s_waitcnt vmcnt(4)
    v_msad_u8 v24, v64, v224, 0
    v_msad_u8 v25, v65, v224, 0
    v_msad_u8 v26, v66, v224, 0
    v_msad_u8 v27, v67, v224, 0
    v_msad_u8 v24, v68, v224, v24
    v_msad_u8 v25, v69, v224, v25
    v_msad_u8 v26, v70, v224, v26
    v_msad_u8 v27, v71, v224, v27
    v_msad_u8 v24, v72, v224, v24
    v_msad_u8 v25, v73, v224, v25
    v_msad_u8 v26, v74, v224, v26
    v_msad_u8 v27, v75, v224, v27
    v_msad_u8 v24, v76, v224, v24
    v_msad_u8 v25, v77, v224, v25
    v_msad_u8 v26, v78, v224, v26
    v_msad_u8 v27, v79, v224, v27
    v_or3_b32 v24, v24, v25, v26
    v_or_b32 v24, v24, v27
    v_cmp_ne_u32 vcc, 0, v24
    v_pk_add_f32 v[80:81], v[64:65], v[68:69]
    v_pk_add_f32 v[82:83], v[66:67], v[70:71]
    v_pk_add_f32 v[84:85], v[72:73], v[76:77]
    v_pk_add_f32 v[86:87], v[74:75], v[78:79]
    v_pk_add_f32 v[80:81], v[80:81], v[32:33]
    v_pk_add_f32 v[82:83], v[82:83], v[34:35]
    v_pk_add_f32 v[80:81], v[80:81], v[84:85]
    v_pk_add_f32 v[82:83], v[82:83], v[86:87]
    s_add_u32 s15, s15, 1
    s_cmp_ge_u32 s15, 65536
    s_cbranch_scc1 L_pollA_done
    s_and_b64 exec, exec, vcc
    s_cbranch_scc0 L_pollA_done
    s_branch L_pollA
L_pollA_done:
    s_mov_b64 exec, -1
    v_permlane16_swap_b32 v80, v81
    v_permlane16_swap_b32 v82, v83
    v_add_f32 v80, v80, v81
    v_add_f32 v82, v82, v83
    s_nop 1
    v_permlane32_swap_b32 v80, v82
    v_add_f32 v80, v80, v82
    s_nop 1
    v_add_f32_dpp v80, v80, v80 row_ror:4 row_mask:0xf bank_mask:0xf
    s_nop 1
    v_add_f32_dpp v80, v80, v80 row_ror:8 row_mask:0xf bank_mask:0xf
    v_cvt_pk_bf16_f32 v12, v80, v80
    s_mov_b32 exec_lo, 0x000f000f
    s_mov_b32 exec_hi, 0x000f000f
    global_store_short v1, v12, s[36:37]
    s_cmp_lg_u32 s6, 0
    s_cbranch_scc1 L_noep
    s_mov_b64 exec, 1
    global_store_dword v6, v224, s[40:41] sc1
L_noep:
L_end:
    s_endpgm
.section .rodata,"a"
.p2align 6
.amdhsa_kernel gated_mix__gqa_block_cached__geglu_ffn__decode_kernel
  .amdhsa_next_free_vgpr 256
  .amdhsa_next_free_sgpr 102
  .amdhsa_accum_offset 256
  .amdhsa_group_segment_fixed_size 0
  .amdhsa_kernarg_size 104
  .amdhsa_user_sgpr_count 2
  .amdhsa_user_sgpr_kernarg_segment_ptr 1
  .amdhsa_system_sgpr_workgroup_id_x 1
.end_amdhsa_kernel
```
